```python
import torch

def _softmax(x, axis=-1):
    return torch.softmax(x, dim=axis)
def _gelu(x):
    return torch.nn.functional.gelu(x, approximate="tanh")
def _silu(x):
    return torch.nn.functional.silu(x)
def _sigmoid(x):
    return torch.sigmoid(x)
def _layernorm(x, axis=-1, eps=1e-5):
    m = x.mean(dim=axis, keepdim=True)
    v = x.var(dim=axis, keepdim=True, unbiased=False)
    return (x - m) / torch.sqrt(v + eps)
def _scatter_add(tgt, idx, src, axis=0):
    return tgt.clone().index_add_(axis, idx, src)
def _segment_sum(src, seg, n):
    out = torch.zeros((n,) + src.shape[1:], dtype=src.dtype)
    return out.index_add_(0, seg, src)
def _pad(x, pw):
    flat = tuple(v for pair in reversed(pw) for v in pair)
    return torch.nn.functional.pad(x, flat)

kernel_name = 'sequential_preLN__ssm_conv_h3__dense_activation_relu__prompt'

def setup_inputs():

    _w = (lambda a: (lambda t: t.to(torch.bfloat16) if t.is_floating_point() else t)(torch.as_tensor(a)))
    def _A_setup():
        B, S, D = 1, 2048, 512
        ks = 4
        return {
            "q": _w((lambda *s: torch.randn(*s, dtype=torch.bfloat16) * 0.05)(B, S, D)),
            "k": _w((lambda *s: torch.randn(*s, dtype=torch.bfloat16) * 0.4)(B, S, D)),
            "v": _w((lambda *s: torch.randn(*s, dtype=torch.bfloat16) * 0.4)(B, S, D)),
            "shift_k": _w((lambda *s: torch.randn(*s, dtype=torch.bfloat16) * 0.4)(D, ks) * 0.5),
            "ssm_k": _w((lambda *s: torch.randn(*s, dtype=torch.bfloat16) * 0.4)(D, S) * (1.0 / S ** 0.5)),
            "ssm_D": _w((lambda *s: torch.randn(*s, dtype=torch.bfloat16) * 0.4)(D)),
        }
    _A_in = _A_setup()

    def _B_setup():
        B, S, D, Dff = 1, 2048, 512, 1792
        return {
            "x": _w((lambda *s: torch.randn(*s, dtype=torch.bfloat16) * 0.05)(B, S, D)),
            "w1": _w((lambda *s: torch.randn(*s, dtype=torch.bfloat16) * 0.05)(D, Dff)),
            "w2": _w((lambda *s: torch.randn(*s, dtype=torch.bfloat16) * 0.05)(Dff, D)),
        }
    _B_in = _B_setup()

    return {
        "A_q": _A_in["q"],
        "A_k": _A_in["k"],
        "A_v": _A_in["v"],
        "A_shift_k": _A_in["shift_k"],
        "A_ssm_k": _A_in["ssm_k"],
        "A_ssm_D": _A_in["ssm_D"],
        "B_x": _B_in["x"],
        "B_w1": _B_in["w1"],
        "B_w2": _B_in["w2"],
    }

def reference(A_q, A_k, A_v, A_shift_k, A_ssm_k, A_ssm_D, B_x, B_w1, B_w2):
    def _A_ref(q, k, v, shift_k, ssm_k, ssm_D):
        B, S, D = q.shape
        ks = shift_k.shape[-1]
        k_pad = _pad(k, ((0, 0), (ks - 1, 0), (0, 0)))
        k_shift = torch.zeros_like(k)
        for t in range(ks):
            k_shift = k_shift + k_pad[:, t:t + S, :] * shift_k[:, ks - 1 - t][None, None, :]
        kv = k_shift * v
        L = 2 * S
        kv_pad = _pad(kv, ((0, 0), (0, S), (0, 0)))
        kf_pad = _pad(ssm_k, ((0, 0), (0, S)))
        kv_f = (lambda x, axes=(-2,-1): torch.fft.rfft2(x.float(), dim=axes))(kv_pad[:, None, :, :], axes=(1, 2))
        kf_f = (lambda x, axes=(-2,-1): torch.fft.rfft2(x.float(), dim=axes))(kf_pad[:, None, :], axes=(1, 2))
        kf_f = (lambda x, *d: x.permute(*d))(kf_f, 1, 2, 0)
        y_f = kv_f * kf_f[None, :, :, :]
        y = (lambda x, s, axes=(-2,-1): torch.fft.irfft2(x, s=s, dim=axes).to(torch.bfloat16))(y_f, (1, L), axes=(1, 2))[:, 0, :S, :]
        y = y + kv * ssm_D[None, None, :]
        return q * y

    def _B_ref(x, w1, w2):
        h = torch.einsum("bsd,df->bsf", x, w1)
        zero = torch.zeros_like(h)
        h = torch.maximum(h, zero)
        return torch.einsum("bsf,fd->bsd", h, w2)

    x = A_q
    h = x + _A_ref(_layernorm(x, axis=-1), A_k, A_v, A_shift_k, A_ssm_k, A_ssm_D)
    h2 = h + _B_ref(_layernorm(h, axis=-1), B_w1, B_w2)
    return h2
```

```asm
; @launch grid=(256,1,1) block=(256,1,1) lds=163840
.amdgcn_target "amdgcn-amd-amdhsa--gfx950"
.text
.globl sequential_preLN__ssm_conv_h3__dense_activation_relu__prompt_kernel
.p2align 8
.type sequential_preLN__ssm_conv_h3__dense_activation_relu__prompt_kernel,@function
sequential_preLN__ssm_conv_h3__dense_activation_relu__prompt_kernel:
    s_cmp_ge_u32 s2, 256
    s_cbranch_scc1 L_END
    s_load_dwordx16 s[4:19], s[0:1], 0
    s_load_dwordx8 s[20:27], s[0:1], 64
    s_getpc_b64 s[30:31]
    s_and_b32 s28, s2, 0xf8
    v_and_b32 v240, 7, v0
    v_add_lshl_u32 v240, v240, s28, 7
    s_mov_b64 exec, 0xff
    global_load_dword v255, v240, s[30:31]
    s_mov_b64 exec, -1
    v_and_b32 v1, 63, v0
    v_lshrrev_b32 v2, 6, v0
    s_and_b32 s68, s2, 7
    v_readfirstlane_b32 s3, v2
    s_lshr_b32 s69, s2, 3
    v_and_b32 v4, 15, v0
    v_lshrrev_b32 v2, 4, v0
    v_lshlrev_b32 v2, 12, v2
    v_lshl_add_u32 v2, v4, 3, v2
    s_lshl_b32 vcc_lo, s69, 16
    s_lshl_b32 vcc_hi, s68, 7
    s_add_u32 vcc_lo, vcc_lo, vcc_hi
    v_add_u32 v2, vcc_lo, v2
    v_add_u32 v3, 0xfffff400, v2
    s_lshl_b32 vcc_lo, s68, 9
    v_lshlrev_b32 v4, 5, v4
    v_add_u32 v4, vcc_lo, v4
    v_lshlrev_b32 v5, 4, v1
    s_mov_b32 s38, 4096
    s_mov_b32 s39, 0x20000
    s_mov_b32 s30, 2097152
    s_mov_b32 s31, 0x20000
    s_mov_b32 s34, 2097152
    s_mov_b32 s35, 0x20000
    s_mov_b32 s42, 2097152
    s_mov_b32 s43, 0x20000
    v_lshrrev_b32 v8, 5, v1
    v_and_b32 v27, 31, v1
    v_lshlrev_b32 v8, 10, v8
    v_lshl_add_u32 v8, v27, 4, v8
    s_waitcnt lgkmcnt(0)
    s_mov_b64 s[28:29], s[6:7]
    buffer_load_dwordx2 v[46:47], v2, s[28:31], 0 offen offset:0 nt
    buffer_load_dwordx2 v[48:49], v2, s[28:31], 0 offen offset:1024 nt
    buffer_load_dwordx2 v[50:51], v2, s[28:31], 0 offen offset:2048 nt
    buffer_load_dwordx2 v[52:53], v2, s[28:31], 0 offen offset:3072 nt
    s_mov_b64 s[36:37], s[10:11]
    buffer_load_dwordx4 v[32:35], v4, s[36:39], 0 offen
    buffer_load_dwordx4 v[36:39], v4, s[36:39], 0 offen offset:16
    s_mov_b64 s[32:33], s[8:9]
    buffer_load_dwordx2 v[54:55], v2, s[32:35], 0 offen offset:0 nt
    buffer_load_dwordx2 v[56:57], v2, s[32:35], 0 offen offset:1024 nt
    buffer_load_dwordx2 v[58:59], v2, s[32:35], 0 offen offset:2048 nt
    buffer_load_dwordx2 v[60:61], v2, s[32:35], 0 offen offset:3072 nt
    buffer_load_dwordx2 v[40:41], v3, s[28:31], 0 offen offset:0 nt
    buffer_load_dwordx2 v[42:43], v3, s[28:31], 0 offen offset:1024 nt
    buffer_load_dwordx2 v[44:45], v3, s[28:31], 0 offen offset:2048 nt
    s_mov_b64 s[40:41], s[4:5]
    s_lshl_b32 s4, s68, 6
    s_lshl_b32 s5, s69, 1
    s_add_u32 s4, s4, s5
    s_lshl_b32 s6, s4, 1
    s_load_dword s17, s[14:15], s6
    s_load_dword s16, s[26:27], 0
    s_lshr_b32 s5, s3, 1
    s_add_u32 s5, s4, s5
    s_lshl_b32 s5, s5, 12
    s_add_u32 s44, s12, s5
    s_addc_u32 s45, s13, 0
    s_mov_b32 s46, 4096
    s_mov_b32 s47, 0x20000
    s_and_b32 vcc_lo, s3, 1
    s_add_u32 s7, s4, vcc_lo
    s_mov_b64 s[48:49], s[26:27]
    s_mov_b32 s50, 18612224
    s_mov_b32 s51, 0x20000
    s_mov_b64 s[60:61], s[22:23]
    s_mov_b32 s62, 2097152
    s_mov_b32 s63, 0x20000
    s_mov_b64 s[52:53], s[18:19]
    s_mov_b32 s54, 1835008
    s_mov_b32 s55, 0x20000
    s_mov_b64 s[56:57], s[20:21]
    s_mov_b32 s58, 1835008
    s_mov_b32 s59, 0x20000
    s_mul_i32 s6, vcc_lo, 4352
    s_add_u32 s6, s6, 155136
    s_lshl_b32 vcc_hi, vcc_lo, 11
    v_add_u32 v7, vcc_hi, v5
    v_add_u32 v6, -16, v7
    s_lshr_b32 s22, s68, 1
    s_lshl_b32 s22, s22, 2
    s_and_b32 s5, s69, 3
    s_add_u32 s22, s22, s5
    s_and_b32 s23, s68, 1
    s_lshl_b32 s23, s23, 3
    s_lshr_b32 s4, s69, 2
    s_add_u32 s23, s23, s4
    s_lshl_b32 s24, s68, 2
    s_add_u32 s24, s24, s5
    s_lshr_b32 s25, s2, 5
    s_lshl_b32 s5, s22, 2
    s_add_u32 s5, s5, s3
    s_lshl_b32 s5, s5, 15
    s_add_u32 s5, s5, 5242880
    s_add_u32 s64, s26, s5
    s_addc_u32 s65, s27, 0
    s_mov_b32 s66, 32768
    s_mov_b32 s67, 0x20000
    s_lshl_b32 s4, s69, 16
    s_lshl_b32 s5, s68, 7
    s_add_u32 s4, s4, s5
    v_subrev_u32 v235, s4, v2
    s_lshl_b32 s4, s24, 16
    s_lshr_b32 s5, s69, 2
    s_lshl_b32 s5, s5, 7
    s_add_u32 s4, s4, s5
    buffer_load_dwordx2 v[62:63], v235, s[40:43], s4 offen offset:0
    buffer_load_dwordx2 v[64:65], v235, s[40:43], s4 offen offset:1024
    buffer_load_dwordx2 v[66:67], v235, s[40:43], s4 offen offset:2048
    buffer_load_dwordx2 v[68:69], v235, s[40:43], s4 offen offset:3072
    s_lshl_b32 s4, s68, 18
    s_lshl_b32 s5, s69, 13
    s_add_u32 s4, s4, s5
    s_lshl_b32 s5, s3, 11
    s_add_u32 s4, s4, s5
    buffer_load_dwordx4 v[70:73], v8, s[40:43], s4 offen offset:0
    buffer_load_dwordx4 v[74:77], v8, s[40:43], s4 offen offset:512
    buffer_load_dwordx4 v[80:83], v6, s[44:47], 0 offen nt
    buffer_load_dwordx4 v[84:87], v7, s[44:47], 0 offen nt
    buffer_load_dwordx4 v[88:91], v7, s[44:47], 0 offen offset:1008 nt
    buffer_load_dwordx4 v[92:95], v7, s[44:47], 0 offen offset:1024 nt
    v_and_b32 v27, 15, v0
    v_lshrrev_b32 v28, 4, v0
    v_and_b32 v29, 7, v0
    v_lshlrev_b32 v30, 1, v29
    v_xor_b32 v28, v28, v30
    v_lshlrev_b32 v27, 9, v27
    v_lshl_add_u32 v10, v28, 3, v27
    v_xor_b32 v28, 15, v28
    v_lshl_add_u32 v9, v28, 3, v27
    v_add_u32 v9, 155136, v9
    v_lshrrev_b32 v28, 5, v0
    v_xor_b32 v28, v28, v29
    v_lshrrev_b32 v30, 3, v0
    v_lshlrev_b32 v11, 7, v30
    v_lshl_add_u32 v11, v28, 4, v11
    v_add_u32 v12, 155136, v11
    v_lshlrev_b32 v13, 12, v30
    v_lshl_add_u32 v13, v29, 4, v13
    s_lshl_b32 s4, s68, 18
    s_lshl_b32 s5, s69, 7
    s_lshr_b32 s10, s69, 2
    s_lshl_b32 s10, s10, 18
    s_lshl_b32 s11, s24, 7
    s_add_u32 s10, s10, s11
    s_add_u32 s10, s10, 3145728
    s_add_u32 s11, s10, 131072
    s_add_u32 s8, s4, 1052544
    s_sub_u32 s8, s8, s5
    s_add_u32 s9, s8, 131072
    v_mov_b32 v251, 0
    v_and_b32 v14, 1, v1
    v_lshlrev_b32 v14, 13, v14
    v_lshrrev_b32 v27, 5, v1
    v_lshl_add_u32 v14, v27, 2, v14
    s_lshl_b32 s12, s68, 10
    s_lshl_b32 s5, s69, 5
    s_add_u32 s12, s12, s5
    s_lshl_b32 s5, s3, 3
    s_add_u32 s12, s12, s5
    s_add_u32 s12, s12, 327680
    v_and_b32 v27, 15, v1
    v_lshrrev_b32 v28, 4, v1
    v_and_b32 v15, 7, v1
    s_movk_i32 s4, 4384
    v_mul_u32_u24 v15, s4, v15
    v_bfe_u32 v29, v1, 3, 1
    v_lshl_add_u32 v15, v29, 8, v15
    v_lshlrev_b32 v29, 4, v28
    v_sub_u32 v15, v15, v29
    s_mul_i32 s5, vcc_lo, 35072
    s_add_u32 s5, s5, 85040
    v_add_u32 v15, s5, v15
    s_lshr_b32 s4, s3, 1
    s_mul_i32 s5, s4, 35072
    s_add_u32 s5, s5, 84992
    v_add_u32 v24, s5, v7
    v_add_u32 v29, v27, v28
    v_lshlrev_b32 v29, 4, v29
    s_add_u32 s5, s6, 288
    v_sub_u32 v16, s5, v29
    v_lshrrev_b32 v29, 5, v1
    v_lshlrev_b32 v29, 7, v29
    v_lshl_add_u32 v29, v27, 3, v29
    v_bfe_u32 v30, v1, 4, 1
    v_lshl_add_u32 v29, v30, 2, v29
    v_lshlrev_b32 v17, 1, v29
    v_lshlrev_b32 v18, 2, v29
    v_add_u32 v236, 8192, v18
    v_lshlrev_b32 v19, 7, v1
    v_add_u32 v19, 98304, v19
    s_cmp_lt_u32 s3, 2
    s_cselect_b32 s26, 2, 0
    s_cselect_b32 s27, 4, 6
    s_add_u32 s5, s6, 4088 - 512
    v_sub_u32 v29, s5, v17
    s_lshl_b32 s4, s26, 9
    v_subrev_u32 v20, s4, v29
    s_lshl_b32 s4, s27, 9
    v_subrev_u32 v21, s4, v29
    v_lshlrev_b32 v22, 3, v30
    v_lshrrev_b32 v29, 5, v1
    v_lshl_add_u32 v22, v29, 2, v22
    v_bfe_u32 v29, v1, 2, 2
    v_add_u32 v22, v22, v29
    v_lshlrev_b32 v22, 15, v22
    v_and_b32 v29, 3, v1
    v_lshl_add_u32 v22, v29, 4, v22
    v_and_b32 v23, 31, v1
    v_lshlrev_b32 v23, 10, v23
    s_lshl_b32 s4, s68, 7
    s_add_u32 s4, s4, 65536
    v_add_u32 v23, s4, v23
    v_lshrrev_b32 v25, 3, v1
    v_lshlrev_b32 v25, 10, v25
    v_lshlrev_b32 v29, 2, v30
    v_and_b32 v31, 7, v1
    v_xor_b32 v29, v29, v31
    v_lshl_add_u32 v25, v29, 4, v25
    v_lshrrev_b32 v29, 5, v1
    v_lshlrev_b32 v29, 3, v29
    v_bfe_u32 v31, v1, 2, 2
    v_add_u32 v29, v29, v31
    v_lshlrev_b32 v29, 7, v29
    v_lshl_add_u32 v29, v30, 5, v29
    v_and_b32 v31, 3, v1
    v_lshl_add_u32 v29, v31, 3, v29
    v_bfe_u32 v31, v1, 3, 1
    v_lshl_add_u32 v26, v31, 6, v29
    s_mul_i32 s13, s3, 458752
    s_lshl_b32 s4, s25, 7
    s_add_u32 s13, s13, s4
    s_mul_i32 s14, s3, 14336
    s_movk_i32 s4, 4682
    s_movk_i32 s5, 3360
    v_add_u32 v240, 0, v1
    v_mul_u32_u24 v31, s4, v240
    v_lshrrev_b32 v31, 16, v31
    v_lshlrev_b32 v240, 4, v240
    v_mad_u32_u24 v240, v31, s5, v240
    v_add_u32 v241, 64, v1
    v_mul_u32_u24 v31, s4, v241
    v_lshrrev_b32 v31, 16, v31
    v_lshlrev_b32 v241, 4, v241
    v_mad_u32_u24 v241, v31, s5, v241
    v_add_u32 v242, 128, v1
    v_mul_u32_u24 v31, s4, v242
    v_lshrrev_b32 v31, 16, v31
    v_lshlrev_b32 v242, 4, v242
    v_mad_u32_u24 v242, v31, s5, v242
    v_add_u32 v243, 192, v1
    v_mul_u32_u24 v31, s4, v243
    v_lshrrev_b32 v31, 16, v31
    v_lshlrev_b32 v243, 4, v243
    v_mad_u32_u24 v243, v31, s5, v243
    v_add_u32 v244, 256, v1
    v_mul_u32_u24 v31, s4, v244
    v_lshrrev_b32 v31, 16, v31
    v_lshlrev_b32 v244, 4, v244
    v_mad_u32_u24 v244, v31, s5, v244
    v_add_u32 v245, 320, v1
    v_mul_u32_u24 v31, s4, v245
    v_lshrrev_b32 v31, 16, v31
    v_lshlrev_b32 v245, 4, v245
    v_mad_u32_u24 v245, v31, s5, v245
    v_add_u32 v246, 384, v1
    v_mul_u32_u24 v31, s4, v246
    v_lshrrev_b32 v31, 16, v31
    v_lshlrev_b32 v246, 4, v246
    v_mad_u32_u24 v246, v31, s5, v246
    s_mul_i32 s15, s3, 114688
    s_mul_i32 s4, s23, 224
    s_add_u32 s15, s15, s4
    s_mul_i32 s20, s3, 7168
    s_mul_i32 s21, s3, 12288
    s_add_u32 s21, s21, 114688
    v_lshlrev_b32 v252, 12, v1
    v_cmp_gt_u32 s[4:5], 9, v1
    v_mov_b32 v29, 0x7ffffff0
    s_nop 0
    v_cndmask_b32 v252, v29, v252, s[4:5]
    v_mov_b32 v180, 0
    v_mov_b32 v181, 0
    v_mov_b32 v182, 0
    v_mov_b32 v183, 0
    v_lshrrev_b32 v29, 4, v0
    s_movk_i32 s4, 4384
    v_and_b32 v31, 15, v0
    v_lshlrev_b32 v31, 4, v31
    v_mad_u32_u24 v29, v29, s4, v31
    v_add_u32 v29, 84992, v29
    ds_write_b128 v29, v[180:183]
    v_add_u32 v247, 159232, v31
    v_mov_b32 v248, 81920
    ds_write_b32 v248, v251
    s_waitcnt vmcnt(19)
    v_lshlrev_b32 v124, 16, v46
    v_and_b32 v125, 0xffff0000, v46
    v_lshlrev_b32 v126, 16, v47
    v_and_b32 v127, 0xffff0000, v47
    v_lshlrev_b32 v128, 16, v48
    v_and_b32 v129, 0xffff0000, v48
    v_lshlrev_b32 v130, 16, v49
    v_and_b32 v131, 0xffff0000, v49
    v_lshlrev_b32 v132, 16, v50
    v_and_b32 v133, 0xffff0000, v50
    v_lshlrev_b32 v134, 16, v51
    v_and_b32 v135, 0xffff0000, v51
    v_lshlrev_b32 v136, 16, v52
    v_and_b32 v137, 0xffff0000, v52
    v_lshlrev_b32 v138, 16, v53
    v_and_b32 v139, 0xffff0000, v53
    s_waitcnt vmcnt(17)
    v_lshlrev_b32 v96, 16, v32
    v_and_b32 v100, 0xffff0000, v32
    v_lshlrev_b32 v104, 16, v33
    v_and_b32 v108, 0xffff0000, v33
    v_lshlrev_b32 v97, 16, v34
    v_and_b32 v101, 0xffff0000, v34
    v_lshlrev_b32 v105, 16, v35
    v_and_b32 v109, 0xffff0000, v35
    v_lshlrev_b32 v98, 16, v36
    v_and_b32 v102, 0xffff0000, v36
    v_lshlrev_b32 v106, 16, v37
    v_and_b32 v110, 0xffff0000, v37
    v_lshlrev_b32 v99, 16, v38
    v_and_b32 v103, 0xffff0000, v38
    v_lshlrev_b32 v107, 16, v39
    v_and_b32 v111, 0xffff0000, v39
    v_pk_mul_f32 v[156:157], v[124:125], v[96:97]
    v_pk_mul_f32 v[158:159], v[126:127], v[98:99]
    v_pk_mul_f32 v[160:161], v[128:129], v[96:97]
    v_pk_mul_f32 v[162:163], v[130:131], v[98:99]
    v_pk_mul_f32 v[164:165], v[132:133], v[96:97]
    v_pk_mul_f32 v[166:167], v[134:135], v[98:99]
    v_pk_mul_f32 v[168:169], v[136:137], v[96:97]
    v_pk_mul_f32 v[170:171], v[138:139], v[98:99]
    v_pk_fma_f32 v[160:161], v[124:125], v[100:101], v[160:161]
    v_pk_fma_f32 v[162:163], v[126:127], v[102:103], v[162:163]
    v_pk_fma_f32 v[164:165], v[128:129], v[100:101], v[164:165]
    v_pk_fma_f32 v[166:167], v[130:131], v[102:103], v[166:167]
    v_pk_fma_f32 v[168:169], v[132:133], v[100:101], v[168:169]
    v_pk_fma_f32 v[170:171], v[134:135], v[102:103], v[170:171]
    v_pk_fma_f32 v[164:165], v[124:125], v[104:105], v[164:165]
    v_pk_fma_f32 v[166:167], v[126:127], v[106:107], v[166:167]
    v_pk_fma_f32 v[168:169], v[128:129], v[104:105], v[168:169]
    v_pk_fma_f32 v[170:171], v[130:131], v[106:107], v[170:171]
    v_pk_fma_f32 v[168:169], v[124:125], v[108:109], v[168:169]
    v_pk_fma_f32 v[170:171], v[126:127], v[110:111], v[170:171]
    s_waitcnt vmcnt(13)
    v_lshlrev_b32 v140, 16, v54
    v_and_b32 v141, 0xffff0000, v54
    v_lshlrev_b32 v142, 16, v55
    v_and_b32 v143, 0xffff0000, v55
    v_lshlrev_b32 v144, 16, v56
    v_and_b32 v145, 0xffff0000, v56
    v_lshlrev_b32 v146, 16, v57
    v_and_b32 v147, 0xffff0000, v57
    v_lshlrev_b32 v148, 16, v58
    v_and_b32 v149, 0xffff0000, v58
    v_lshlrev_b32 v150, 16, v59
    v_and_b32 v151, 0xffff0000, v59
    v_lshlrev_b32 v152, 16, v60
    v_and_b32 v153, 0xffff0000, v60
    v_lshlrev_b32 v154, 16, v61
    v_and_b32 v155, 0xffff0000, v61
    s_waitcnt vmcnt(10)
    v_lshlrev_b32 v112, 16, v40
    v_and_b32 v113, 0xffff0000, v40
    v_lshlrev_b32 v114, 16, v41
    v_and_b32 v115, 0xffff0000, v41
    v_lshlrev_b32 v116, 16, v42
    v_and_b32 v117, 0xffff0000, v42
    v_lshlrev_b32 v118, 16, v43
    v_and_b32 v119, 0xffff0000, v43
    v_lshlrev_b32 v120, 16, v44
    v_and_b32 v121, 0xffff0000, v44
    v_lshlrev_b32 v122, 16, v45
    v_and_b32 v123, 0xffff0000, v45
    v_pk_fma_f32 v[156:157], v[120:121], v[100:101], v[156:157]
    v_pk_fma_f32 v[158:159], v[122:123], v[102:103], v[158:159]
    v_pk_fma_f32 v[156:157], v[116:117], v[104:105], v[156:157]
    v_pk_fma_f32 v[158:159], v[118:119], v[106:107], v[158:159]
    v_pk_fma_f32 v[160:161], v[120:121], v[104:105], v[160:161]
    v_pk_fma_f32 v[162:163], v[122:123], v[106:107], v[162:163]
    v_pk_fma_f32 v[156:157], v[112:113], v[108:109], v[156:157]
    v_pk_fma_f32 v[158:159], v[114:115], v[110:111], v[158:159]
    v_pk_fma_f32 v[160:161], v[116:117], v[108:109], v[160:161]
    v_pk_fma_f32 v[162:163], v[118:119], v[110:111], v[162:163]
    v_pk_fma_f32 v[164:165], v[120:121], v[108:109], v[164:165]
    v_pk_fma_f32 v[166:167], v[122:123], v[110:111], v[166:167]
    v_pk_mul_f32 v[168:169], v[168:169], v[152:153]
    v_pk_mul_f32 v[170:171], v[170:171], v[154:155]
    v_pk_mul_f32 v[164:165], v[164:165], v[148:149]
    v_pk_mul_f32 v[166:167], v[166:167], v[150:151]
    v_pk_mul_f32 v[160:161], v[160:161], v[144:145]
    v_pk_mul_f32 v[162:163], v[162:163], v[146:147]
    v_pk_mul_f32 v[156:157], v[156:157], v[140:141]
    v_pk_mul_f32 v[158:159], v[158:159], v[142:143]
    v_cvt_pk_bf16_f32 v172, v168, v164
    v_cvt_pk_bf16_f32 v173, v160, v156
    ds_write_b64 v9, v[172:173] offset:0
    v_cvt_pk_bf16_f32 v174, v169, v165
    v_cvt_pk_bf16_f32 v175, v161, v157
    ds_write_b64 v9, v[174:175] offset:128
    v_cvt_pk_bf16_f32 v176, v170, v166
    v_cvt_pk_bf16_f32 v177, v162, v158
    ds_write_b64 v9, v[176:177] offset:256
    v_cvt_pk_bf16_f32 v178, v171, v167
    v_cvt_pk_bf16_f32 v179, v163, v159
    ds_write_b64 v9, v[178:179] offset:384
    s_waitcnt lgkmcnt(0)
    s_barrier
    ds_read_b128 v[180:183], v12
    ds_read_b128 v[184:187], v12 offset:4096
    s_mul_i32 s18, s16, 1664525
    s_add_u32 s18, s18, 1013904223
    s_mov_b32 s4, 0x05040100
    s_mov_b32 s5, 0x07060302
    v_mov_b32 v250, s18
    s_waitcnt lgkmcnt(1)
    buffer_store_dwordx4 v[180:183], v13, s[48:51], s8 offen sc1
    s_waitcnt lgkmcnt(0)
    buffer_store_dwordx4 v[184:187], v13, s[48:51], s9 offen sc1
    s_waitcnt vmcnt(8)
    v_perm_b32 v172, v64, v62, s4
    v_perm_b32 v173, v68, v66, s4
    ds_write_b64 v10, v[172:173] offset:0
    v_perm_b32 v174, v64, v62, s5
    v_perm_b32 v175, v68, v66, s5
    ds_write_b64 v10, v[174:175] offset:128
    v_perm_b32 v176, v65, v63, s4
    v_perm_b32 v177, v69, v67, s4
    ds_write_b64 v10, v[176:177] offset:256
    v_perm_b32 v178, v65, v63, s5
    v_perm_b32 v179, v69, v67, s5
    ds_write_b64 v10, v[178:179] offset:384
    s_waitcnt lgkmcnt(0)
    s_barrier
    ds_read_b128 v[188:191], v11 offset:0
    ds_read_b128 v[192:195], v11 offset:4096
    s_waitcnt vmcnt(6)
    v_lshlrev_b32 v112, 16, v70
    v_and_b32 v113, 0xffff0000, v70
    v_lshlrev_b32 v114, 16, v71
    v_and_b32 v115, 0xffff0000, v71
    v_lshlrev_b32 v116, 16, v72
    v_and_b32 v117, 0xffff0000, v72
    v_lshlrev_b32 v118, 16, v73
    v_and_b32 v119, 0xffff0000, v73
    s_waitcnt lgkmcnt(1)
    buffer_store_dwordx4 v[188:191], v13, s[48:51], s10 offen sc1
    v_lshlrev_b32 v120, 16, v74
    v_and_b32 v121, 0xffff0000, v74
    v_lshlrev_b32 v122, 16, v75
    v_and_b32 v123, 0xffff0000, v75
    v_lshlrev_b32 v124, 16, v76
    v_and_b32 v125, 0xffff0000, v76
    v_lshlrev_b32 v126, 16, v77
    v_and_b32 v127, 0xffff0000, v77
    s_waitcnt lgkmcnt(0)
    buffer_store_dwordx4 v[192:195], v13, s[48:51], s11 offen sc1
    v_pk_add_f32 v[128:129], v[112:113], v[114:115]
    v_pk_mul_f32 v[130:131], v[112:113], v[112:113]
    v_pk_fma_f32 v[130:131], v[114:115], v[114:115], v[130:131]
    v_pk_add_f32 v[128:129], v[128:129], v[116:117]
    v_pk_fma_f32 v[130:131], v[116:117], v[116:117], v[130:131]
    v_pk_add_f32 v[128:129], v[128:129], v[118:119]
    v_pk_fma_f32 v[130:131], v[118:119], v[118:119], v[130:131]
    v_pk_add_f32 v[128:129], v[128:129], v[120:121]
    v_pk_fma_f32 v[130:131], v[120:121], v[120:121], v[130:131]
    v_pk_add_f32 v[128:129], v[128:129], v[122:123]
    v_pk_fma_f32 v[130:131], v[122:123], v[122:123], v[130:131]
    v_pk_add_f32 v[128:129], v[128:129], v[124:125]
    v_pk_fma_f32 v[130:131], v[124:125], v[124:125], v[130:131]
    v_pk_add_f32 v[128:129], v[128:129], v[126:127]
    v_pk_fma_f32 v[130:131], v[126:127], v[126:127], v[130:131]
    v_add_f32 v128, v128, v129
    v_add_f32 v129, v130, v131
    s_nop 0
    v_add_f32_dpp v128, v128, v128 quad_perm:[1,0,3,2] row_mask:0xf bank_mask:0xf
    v_add_f32_dpp v129, v129, v129 quad_perm:[1,0,3,2] row_mask:0xf bank_mask:0xf
    s_nop 0
    v_add_f32_dpp v128, v128, v128 quad_perm:[2,3,0,1] row_mask:0xf bank_mask:0xf
    v_add_f32_dpp v129, v129, v129 quad_perm:[2,3,0,1] row_mask:0xf bank_mask:0xf
    s_nop 0
    v_add_f32_dpp v128, v128, v128 row_half_mirror row_mask:0xf bank_mask:0xf
    v_add_f32_dpp v129, v129, v129 row_half_mirror row_mask:0xf bank_mask:0xf
    s_nop 0
    v_add_f32_dpp v128, v128, v128 row_mirror row_mask:0xf bank_mask:0xf
    v_add_f32_dpp v129, v129, v129 row_mirror row_mask:0xf bank_mask:0xf
    v_mov_b32 v130, v128
    v_mov_b32 v131, v129
    s_nop 0
    v_permlane16_swap_b32 v128, v130
    v_permlane16_swap_b32 v129, v131
    v_pk_add_f32 v[128:129], v[128:129], v[130:131]
    v_mul_f32 v128, 0x3b000000, v128
    v_mul_f32 v129, 0x3b000000, v129
    v_fma_f32 v129, -v128, v128, v129
    v_max_f32 v129, 0, v129
    v_cvt_pk_bf16_f32 v128, v128, v128
    v_and_b32 v128, 0xffff0000, v128
    v_cvt_pk_bf16_f32 v129, v129, v129
    v_and_b32 v129, 0xffff0000, v129
    v_add_f32 v129, 0x3727c5ac, v129
    v_cvt_pk_bf16_f32 v129, v129, v129
    v_and_b32 v129, 0xffff0000, v129
    v_sqrt_f32 v129, v129
    s_nop 0
    v_cvt_pk_bf16_f32 v129, v129, v129
    v_and_b32 v129, 0xffff0000, v129
    v_rcp_f32 v129, v129
    s_mov_b32 vcc_lo, 0xaaaaaaaa
    s_mov_b32 vcc_hi, 0xaaaaaaaa
    v_mul_f32 v128, v128, -v129
    v_cndmask_b32 v128, v129, v128, vcc
    s_mov_b32 exec_lo, 3
    s_mov_b32 exec_hi, 3
    buffer_store_dword v128, v14, s[48:51], s12 offen sc1
    s_mov_b64 exec, -1
    s_lshl_b32 s36, s7, 12
    s_add_u32 s36, s36, 3145728
    s_lshl_b32 s37, s7, 6
    s_add_u32 s37, s37, 5242880
    s_lshl_b32 s38, s26, 9
    s_add_u32 s28, s38, s36
    s_lshl_b32 s38, s26, 10
    s_add_u32 s30, s38, 327680
    s_lshl_b32 s38, s26, 18
    s_add_u32 s32, s38, s37
    s_lshl_b32 s38, s27, 9
    s_add_u32 s29, s38, s36
    s_lshl_b32 s38, s27, 10
    s_add_u32 s31, s38, 327680
    s_lshl_b32 s38, s27, 18
    s_add_u32 s33, s38, s37
    s_lshl_b32 s34, s7, 12
    s_add_u32 s34, s34, 1048576
    s_and_b32 s35, s2, 63
    s_lshl_b32 s35, s35, 7
    s_lshr_b32 s38, s2, 6
    s_lshl_b32 s38, s38, 2
    s_add_u32 s35, s35, s38
    s_add_u32 s35, s35, 98304
    s_and_b32 s38, s3, 1
    s_lshl_b32 s38, s38, 4
    s_lshr_b32 s26, s17, s38
    s_lshl_b32 s26, s26, 16
    s_mov_b32 s27, s26
    v_mov_b32 v156, 0
    v_mov_b32 v157, 0
    v_mov_b32 v158, 0
    v_mov_b32 v159, 0
    v_mov_b32 v249, 1
    s_and_b32 s38, s24, 3
    s_lshl_b32 s38, s38, 10
    s_add_u32 s41, s13, s38
    s_add_u32 s41, s41, 163840
    s_sub_u32 s13, s13, 8192
    s_lshl_b32 s38, s2, 7
    s_add_u32 s38, s38, 65536
    s_waitcnt vmcnt(3)
    s_barrier
    s_cmp_lg_u32 s3, 0
    s_cbranch_scc1 L_NF1
    s_mov_b64 exec, 1
    buffer_store_dword v250, v251, s[48:51], s38 offen sc1
    s_mov_b64 exec, -1
L_NF1:
    s_mov_b64 exec, 0xffff
    ds_write_b128 v247, v[156:159]
    ds_write_b128 v247, v[156:159] offset:4352
    s_mov_b64 exec, -1
    s_cmp_ge_u32 s3, 2
    s_cbranch_scc1 L_ROLEA
    ds_write_b128 v24, v[82:85] offset:13408
    ds_write_b128 v24, v[84:87] offset:30944
    v_alignbit_b32 v196, v81, v80, 16
    v_alignbit_b32 v197, v82, v81, 16
    v_alignbit_b32 v198, v83, v82, 16
    v_alignbit_b32 v199, v84, v83, 16
    v_alignbit_b32 v200, v85, v84, 16
    v_alignbit_b32 v201, v86, v85, 16
    v_alignbit_b32 v202, v82, v81, 16
    v_alignbit_b32 v203, v83, v82, 16
    v_alignbit_b32 v204, v84, v83, 16
    v_alignbit_b32 v205, v85, v84, 16
    v_alignbit_b32 v206, v86, v85, 16
    v_alignbit_b32 v207, v87, v86, 16
    v_mov_b32 v208, v81
    v_mov_b32 v209, v82
    v_mov_b32 v210, v83
    v_mov_b32 v211, v84
    v_mov_b32 v212, v85
    v_mov_b32 v213, v86
    ds_write_b128 v24, v[196:199] offset:256
    ds_write_b128 v24, v[198:201] offset:17792
    ds_write_b128 v24, v[202:205] offset:9024
    ds_write_b128 v24, v[204:207] offset:26560
    ds_write_b128 v24, v[208:211] offset:4640
    ds_write_b128 v24, v[210:213] offset:22176
    ds_write_b128 v24, v[90:93] offset:14432
    ds_write_b128 v24, v[92:95] offset:31968
    v_alignbit_b32 v214, v89, v88, 16
    v_alignbit_b32 v215, v90, v89, 16
    v_alignbit_b32 v216, v91, v90, 16
    v_alignbit_b32 v217, v92, v91, 16
    v_alignbit_b32 v218, v93, v92, 16
    v_alignbit_b32 v219, v94, v93, 16
    v_alignbit_b32 v220, v90, v89, 16
    v_alignbit_b32 v221, v91, v90, 16
    v_alignbit_b32 v222, v92, v91, 16
    v_alignbit_b32 v223, v93, v92, 16
    v_alignbit_b32 v224, v94, v93, 16
    v_alignbit_b32 v225, v95, v94, 16
    v_mov_b32 v226, v89
    v_mov_b32 v227, v90
    v_mov_b32 v228, v91
    v_mov_b32 v229, v92
    v_mov_b32 v230, v93
    v_mov_b32 v231, v94
    ds_write_b128 v24, v[214:217] offset:1280
    ds_write_b128 v24, v[216:219] offset:18816
    ds_write_b128 v24, v[220:223] offset:10048
    ds_write_b128 v24, v[222:225] offset:27584
    ds_write_b128 v24, v[226:229] offset:5664
    ds_write_b128 v24, v[228:231] offset:23200
    buffer_load_dword v29, v23, s[48:51], 0 offen sc1
    s_waitcnt vmcnt(1)
    s_mov_b64 exec, 1
    ds_add_rtn_u32 v249, v248, v249
    s_waitcnt lgkmcnt(0)
    v_cmp_ne_u32 vcc, 3, v249
    s_nop 0
    s_cmp_eq_u64 vcc, 0
    s_cselect_b32 s35, s35, 0x7ffffff0
    buffer_store_dword v250, v251, s[48:51], s35 offen sc1
    s_mov_b64 exec, -1
    s_mov_b32 s19, 0
    s_waitcnt vmcnt(1)
    s_branch PCHK_3
POLL_1:
    s_mov_b64 exec, vcc
    buffer_load_dword v29, v23, s[48:51], 0 offen sc1
    s_add_u32 s19, s19, 1
    s_waitcnt vmcnt(0)
PCHK_3:
    v_cmp_ne_u32 vcc, s18, v29
    s_cbranch_vccz PDONE_2
    s_cmp_lt_u32 s19, 65536
    s_cbranch_scc1 POLL_1
PDONE_2:
    s_mov_b64 exec, -1
    s_mov_b32 m0, s6
    s_nop 0
    buffer_load_dwordx4 v5, s[48:51], s34 offen offset:0 sc1 lds
    buffer_load_dwordx4 v5, s[48:51], s34 offen offset:1024 sc1 lds
    buffer_load_dwordx4 v5, s[48:51], s34 offen offset:2048 sc1 lds
    buffer_load_dwordx4 v5, s[48:51], s34 offen offset:3072 sc1 lds
    s_waitcnt vmcnt(0) lgkmcnt(0)
    s_barrier
    ds_read_b128 v[64:67], v15 offset:0
    ds_read_b128 v[96:99], v16 offset:3584
    ds_read_b128 v[68:71], v15 offset:512
    ds_read_b128 v[100:103], v16 offset:3072
    ds_read_b128 v[72:75], v15 offset:1024
    ds_read_b128 v[104:107], v16 offset:2560
    ds_read_b128 v[76:79], v15 offset:1536
    ds_read_b128 v[108:111], v16 offset:2048
    ds_read_b128 v[80:83], v15 offset:2048
    ds_read_b128 v[112:115], v16 offset:1536
    ds_read_b128 v[84:87], v15 offset:2560
    ds_read_b128 v[116:119], v16 offset:1024
    buffer_load_dwordx4 v[224:227], v19, s[48:51], 0 offen sc1
    s_waitcnt lgkmcnt(8)
    v_mfma_f32_16x16x32_bf16 v[32:35], v[68:71], v[100:103], 0
    s_waitcnt lgkmcnt(6)
    v_mfma_f32_16x16x32_bf16 v[32:35], v[64:67], v[104:107], v[32:35]
    v_mfma_f32_16x16x32_bf16 v[36:39], v[68:71], v[104:107], 0
    v_mfma_f32_16x16x32_bf16 v[32:35], v[72:75], v[96:99], v[32:35]
    v_mfma_f32_16x16x32_bf16 v[36:39], v[72:75], v[100:103], v[36:39]
    ds_read_b128 v[128:131], v15 offset:64
    ds_read_b128 v[160:163], v16 offset:3648
    v_mfma_f32_16x16x32_bf16 v[40:43], v[72:75], v[104:107], 0
    ds_read_b128 v[132:135], v15 offset:576
    ds_read_b128 v[164:167], v16 offset:3136
    s_waitcnt lgkmcnt(8)
    v_mfma_f32_16x16x32_bf16 v[36:39], v[64:67], v[108:111], v[36:39]
    ds_read_b128 v[136:139], v15 offset:1088
    ds_read_b128 v[168:171], v16 offset:2624
    v_mfma_f32_16x16x32_bf16 v[40:43], v[68:71], v[108:111], v[40:43]
    ds_read_b128 v[140:143], v15 offset:1600
    ds_read_b128 v[172:175], v16 offset:2112
    v_mfma_f32_16x16x32_bf16 v[44:47], v[72:75], v[108:111], 0
    ds_read_b128 v[144:147], v15 offset:2112
    ds_read_b128 v[176:179], v16 offset:1600
    v_mfma_f32_16x16x32_bf16 v[36:39], v[76:79], v[96:99], v[36:39]
    ds_read_b128 v[148:151], v15 offset:2624
    ds_read_b128 v[180:183], v16 offset:1088
    v_mfma_f32_16x16x32_bf16 v[40:43], v[76:79], v[100:103], v[40:43]
    s_add_u32 s36, s15, 0
    s_add_u32 m0, s20, 0
    s_nop 0
    buffer_load_dwordx4 v240, s[52:55], s36 offen lds
    v_mfma_f32_16x16x32_bf16 v[44:47], v[76:79], v[104:107], v[44:47]
    s_waitcnt lgkmcnt(14)
    v_mfma_f32_16x16x32_bf16 v[40:43], v[64:67], v[112:115], v[40:43]
    v_mfma_f32_16x16x32_bf16 v[44:47], v[68:71], v[112:115], v[44:47]
    v_mfma_f32_16x16x32_bf16 v[40:43], v[80:83], v[96:99], v[40:43]
    s_add_u32 m0, s20, 1024
    s_nop 0
    buffer_load_dwordx4 v241, s[52:55], s36 offen lds
    v_mfma_f32_16x16x32_bf16 v[44:47], v[80:83], v[100:103], v[44:47]
    s_waitcnt lgkmcnt(12)
    v_mfma_f32_16x16x32_bf16 v[44:47], v[64:67], v[116:119], v[44:47]
    v_mfma_f32_16x16x32_bf16 v[44:47], v[84:87], v[96:99], v[44:47]
    s_waitcnt lgkmcnt(0)
    v_mfma_f32_16x16x32_bf16 v[32:35], v[132:135], v[164:167], v[32:35]
    ds_read_b128 v[64:67], v15 offset:128
    ds_read_b128 v[96:99], v16 offset:3712
    v_mfma_f32_16x16x32_bf16 v[32:35], v[128:131], v[168:171], v[32:35]
    ds_read_b128 v[68:71], v15 offset:640
    ds_read_b128 v[100:103], v16 offset:3200
    v_mfma_f32_16x16x32_bf16 v[36:39], v[132:135], v[168:171], v[36:39]
    ds_read_b128 v[72:75], v15 offset:1152
    ds_read_b128 v[104:107], v16 offset:2688
    v_mfma_f32_16x16x32_bf16 v[32:35], v[136:139], v[160:163], v[32:35]
    ds_read_b128 v[76:79], v15 offset:1664
    ds_read_b128 v[108:111], v16 offset:2176
    v_mfma_f32_16x16x32_bf16 v[36:39], v[136:139], v[164:167], v[36:39]
    ds_read_b128 v[80:83], v15 offset:2176
    ds_read_b128 v[112:115], v16 offset:1664
    v_mfma_f32_16x16x32_bf16 v[40:43], v[136:139], v[168:171], v[40:43]
    ds_read_b128 v[84:87], v15 offset:2688
    ds_read_b128 v[116:119], v16 offset:1152
    v_mfma_f32_16x16x32_bf16 v[36:39], v[128:131], v[172:175], v[36:39]
    s_add_u32 m0, s20, 2048
    s_nop 0
    buffer_load_dwordx4 v242, s[52:55], s36 offen lds
    v_mfma_f32_16x16x32_bf16 v[40:43], v[132:135], v[172:175], v[40:43]
    v_mfma_f32_16x16x32_bf16 v[44:47], v[136:139], v[172:175], v[44:47]
    v_mfma_f32_16x16x32_bf16 v[36:39], v[140:143], v[160:163], v[36:39]
    v_mfma_f32_16x16x32_bf16 v[40:43], v[140:143], v[164:167], v[40:43]
    v_mfma_f32_16x16x32_bf16 v[44:47], v[140:143], v[168:171], v[44:47]
    v_mfma_f32_16x16x32_bf16 v[40:43], v[128:131], v[176:179], v[40:43]
    s_add_u32 m0, s20, 3072
    s_nop 0
    buffer_load_dwordx4 v243, s[52:55], s36 offen lds
    v_mfma_f32_16x16x32_bf16 v[44:47], v[132:135], v[176:179], v[44:47]
    v_mfma_f32_16x16x32_bf16 v[40:43], v[144:147], v[160:163], v[40:43]
    v_mfma_f32_16x16x32_bf16 v[44:47], v[144:147], v[164:167], v[44:47]
    v_mfma_f32_16x16x32_bf16 v[44:47], v[128:131], v[180:183], v[44:47]
    v_mfma_f32_16x16x32_bf16 v[44:47], v[148:151], v[160:163], v[44:47]
    s_mov_b32 s19, 0
    s_waitcnt vmcnt(4)
    s_branch PCHK_6
POLL_4:
    s_mov_b64 exec, vcc
    buffer_load_dwordx4 v[224:227], v19, s[48:51], 0 offen sc1
    s_add_u32 s19, s19, 1
    s_waitcnt vmcnt(0)
PCHK_6:
    v_xor_b32 v224, s18, v224
    v_xor_b32 v225, s18, v225
    v_xor_b32 v226, s18, v226
    v_xor_b32 v227, s18, v227
    v_or3_b32 v224, v224, v225, v226
    v_or_b32 v224, v224, v227
    v_cmp_ne_u32 vcc, 0, v224
    s_cbranch_vccz PDONE_5
    s_cmp_lt_u32 s19, 65536
    s_cbranch_scc1 POLL_4
PDONE_5:
    s_mov_b64 exec, -1
    s_waitcnt lgkmcnt(0)
    v_mfma_f32_16x16x32_bf16 v[32:35], v[68:71], v[100:103], v[32:35]
    ds_read_b128 v[128:131], v15 offset:192
    ds_read_b128 v[160:163], v16 offset:3776
    v_mfma_f32_16x16x32_bf16 v[32:35], v[64:67], v[104:107], v[32:35]
    ds_read_b128 v[132:135], v15 offset:704
    ds_read_b128 v[164:167], v16 offset:3264
    v_mfma_f32_16x16x32_bf16 v[36:39], v[68:71], v[104:107], v[36:39]
    ds_read_b128 v[136:139], v15 offset:1216
    ds_read_b128 v[168:171], v16 offset:2752
    v_mfma_f32_16x16x32_bf16 v[32:35], v[72:75], v[96:99], v[32:35]
    ds_read_b128 v[140:143], v15 offset:1728
    ds_read_b128 v[172:175], v16 offset:2240
    v_mfma_f32_16x16x32_bf16 v[36:39], v[72:75], v[100:103], v[36:39]
    ds_read_b128 v[144:147], v15 offset:2240
    ds_read_b128 v[176:179], v16 offset:1728
    v_mfma_f32_16x16x32_bf16 v[40:43], v[72:75], v[104:107], v[40:43]
    ds_read_b128 v[148:151], v15 offset:2752
    ds_read_b128 v[180:183], v16 offset:1216
    v_mfma_f32_16x16x32_bf16 v[36:39], v[64:67], v[108:111], v[36:39]
    buffer_load_dwordx2 v[48:49], v17, s[48:51], s28 offen offset:0 sc1
    v_mfma_f32_16x16x32_bf16 v[40:43], v[68:71], v[108:111], v[40:43]
    v_mfma_f32_16x16x32_bf16 v[44:47], v[72:75], v[108:111], v[44:47]
    buffer_load_dwordx4 v[192:195], v18, s[48:51], s30 offen offset:0 sc1
    v_mfma_f32_16x16x32_bf16 v[36:39], v[76:79], v[96:99], v[36:39]
    v_mfma_f32_16x16x32_bf16 v[40:43], v[76:79], v[100:103], v[40:43]
    buffer_load_dwordx4 v[196:199], v236, s[48:51], s30 offen offset:0 sc1
    v_mfma_f32_16x16x32_bf16 v[44:47], v[76:79], v[104:107], v[44:47]
    v_mfma_f32_16x16x32_bf16 v[40:43], v[64:67], v[112:115], v[40:43]
    v_mfma_f32_16x16x32_bf16 v[44:47], v[68:71], v[112:115], v[44:47]
    buffer_load_dwordx2 v[50:51], v17, s[48:51], s28 offen offset:512 sc1
    v_mfma_f32_16x16x32_bf16 v[40:43], v[80:83], v[96:99], v[40:43]
    v_mfma_f32_16x16x32_bf16 v[44:47], v[80:83], v[100:103], v[44:47]
    s_add_u32 m0, s20, 4096
    s_nop 0
    buffer_load_dwordx4 v244, s[52:55], s36 offen lds
    v_mfma_f32_16x16x32_bf16 v[44:47], v[64:67], v[116:119], v[44:47]
    v_mfma_f32_16x16x32_bf16 v[44:47], v[84:87], v[96:99], v[44:47]
    s_waitcnt lgkmcnt(0)
    v_mfma_f32_16x16x32_bf16 v[32:35], v[132:135], v[164:167], v[32:35]
    ds_read_b128 v[64:67], v15 offset:256
    ds_read_b128 v[96:99], v16 offset:3840
    v_mfma_f32_16x16x32_bf16 v[32:35], v[128:131], v[168:171], v[32:35]
    ds_read_b128 v[68:71], v15 offset:768
    ds_read_b128 v[100:103], v16 offset:3328
    v_mfma_f32_16x16x32_bf16 v[36:39], v[132:135], v[168:171], v[36:39]
    ds_read_b128 v[72:75], v15 offset:1280
    ds_read_b128 v[104:107], v16 offset:2816
    v_mfma_f32_16x16x32_bf16 v[32:35], v[136:139], v[160:163], v[32:35]
    ds_read_b128 v[76:79], v15 offset:1792
    ds_read_b128 v[108:111], v16 offset:2304
    v_mfma_f32_16x16x32_bf16 v[36:39], v[136:139], v[164:167], v[36:39]
    ds_read_b128 v[80:83], v15 offset:2304
    ds_read_b128 v[112:115], v16 offset:1792
    v_mfma_f32_16x16x32_bf16 v[40:43], v[136:139], v[168:171], v[40:43]
    ds_read_b128 v[84:87], v15 offset:2816
    ds_read_b128 v[116:119], v16 offset:1280
    v_mfma_f32_16x16x32_bf16 v[36:39], v[128:131], v[172:175], v[36:39]
    buffer_load_dwordx4 v[200:203], v18, s[48:51], s30 offen offset:1024 sc1
    v_mfma_f32_16x16x32_bf16 v[40:43], v[132:135], v[172:175], v[40:43]
    v_mfma_f32_16x16x32_bf16 v[44:47], v[136:139], v[172:175], v[44:47]
    buffer_load_dwordx4 v[204:207], v236, s[48:51], s30 offen offset:1024 sc1
    v_mfma_f32_16x16x32_bf16 v[36:39], v[140:143], v[160:163], v[36:39]
    v_mfma_f32_16x16x32_bf16 v[40:43], v[140:143], v[164:167], v[40:43]
    buffer_load_dwordx2 v[52:53], v17, s[48:51], s29 offen offset:0 sc1
    v_mfma_f32_16x16x32_bf16 v[44:47], v[140:143], v[168:171], v[44:47]
    v_mfma_f32_16x16x32_bf16 v[40:43], v[128:131], v[176:179], v[40:43]
    v_mfma_f32_16x16x32_bf16 v[44:47], v[132:135], v[176:179], v[44:47]
    buffer_load_dwordx4 v[208:211], v18, s[48:51], s31 offen offset:0 sc1
    v_mfma_f32_16x16x32_bf16 v[40:43], v[144:147], v[160:163], v[40:43]
    v_mfma_f32_16x16x32_bf16 v[44:47], v[144:147], v[164:167], v[44:47]
    s_add_u32 m0, s20, 5120
    s_nop 0
    buffer_load_dwordx4 v245, s[52:55], s36 offen lds
    v_mfma_f32_16x16x32_bf16 v[44:47], v[128:131], v[180:183], v[44:47]
    v_mfma_f32_16x16x32_bf16 v[44:47], v[148:151], v[160:163], v[44:47]
    s_waitcnt lgkmcnt(0)
    v_mfma_f32_16x16x32_bf16 v[32:35], v[68:71], v[100:103], v[32:35]
    ds_read_b128 v[128:131], v15 offset:320
    ds_read_b128 v[160:163], v16 offset:3904
    v_mfma_f32_16x16x32_bf16 v[32:35], v[64:67], v[104:107], v[32:35]
    ds_read_b128 v[132:135], v15 offset:832
    ds_read_b128 v[164:167], v16 offset:3392
    v_mfma_f32_16x16x32_bf16 v[36:39], v[68:71], v[104:107], v[36:39]
    ds_read_b128 v[136:139], v15 offset:1344
    ds_read_b128 v[168:171], v16 offset:2880
    v_mfma_f32_16x16x32_bf16 v[32:35], v[72:75], v[96:99], v[32:35]
    ds_read_b128 v[140:143], v15 offset:1856
    ds_read_b128 v[172:175], v16 offset:2368
    v_mfma_f32_16x16x32_bf16 v[36:39], v[72:75], v[100:103], v[36:39]
    ds_read_b128 v[144:147], v15 offset:2368
    ds_read_b128 v[176:179], v16 offset:1856
    v_mfma_f32_16x16x32_bf16 v[40:43], v[72:75], v[104:107], v[40:43]
    ds_read_b128 v[148:151], v15 offset:2880
    ds_read_b128 v[180:183], v16 offset:1344
    v_mfma_f32_16x16x32_bf16 v[36:39], v[64:67], v[108:111], v[36:39]
    buffer_load_dwordx4 v[212:215], v236, s[48:51], s31 offen offset:0 sc1
    v_mfma_f32_16x16x32_bf16 v[40:43], v[68:71], v[108:111], v[40:43]
    v_mfma_f32_16x16x32_bf16 v[44:47], v[72:75], v[108:111], v[44:47]
    buffer_load_dwordx2 v[54:55], v17, s[48:51], s29 offen offset:512 sc1
    v_mfma_f32_16x16x32_bf16 v[36:39], v[76:79], v[96:99], v[36:39]
    v_mfma_f32_16x16x32_bf16 v[40:43], v[76:79], v[100:103], v[40:43]
    buffer_load_dwordx4 v[216:219], v18, s[48:51], s31 offen offset:1024 sc1
    v_mfma_f32_16x16x32_bf16 v[44:47], v[76:79], v[104:107], v[44:47]
    v_mfma_f32_16x16x32_bf16 v[40:43], v[64:67], v[112:115], v[40:43]
    v_mfma_f32_16x16x32_bf16 v[44:47], v[68:71], v[112:115], v[44:47]
    buffer_load_dwordx4 v[220:223], v236, s[48:51], s31 offen offset:1024 sc1
    v_mfma_f32_16x16x32_bf16 v[40:43], v[80:83], v[96:99], v[40:43]
    v_mfma_f32_16x16x32_bf16 v[44:47], v[80:83], v[100:103], v[44:47]
    s_add_u32 m0, s20, 6144
    s_nop 0
    buffer_load_dwordx4 v246, s[52:55], s36 offen lds
    v_mfma_f32_16x16x32_bf16 v[44:47], v[64:67], v[116:119], v[44:47]
    v_mfma_f32_16x16x32_bf16 v[44:47], v[84:87], v[96:99], v[44:47]
    s_waitcnt lgkmcnt(0)
    v_mfma_f32_16x16x32_bf16 v[32:35], v[132:135], v[164:167], v[32:35]
    ds_read_b128 v[64:67], v15 offset:384
    ds_read_b128 v[96:99], v16 offset:3968
    v_mfma_f32_16x16x32_bf16 v[32:35], v[128:131], v[168:171], v[32:35]
    ds_read_b128 v[68:71], v15 offset:896
    ds_read_b128 v[100:103], v16 offset:3456
    v_mfma_f32_16x16x32_bf16 v[36:39], v[132:135], v[168:171], v[36:39]
    ds_read_b128 v[72:75], v15 offset:1408
    ds_read_b128 v[104:107], v16 offset:2944
    v_mfma_f32_16x16x32_bf16 v[32:35], v[136:139], v[160:163], v[32:35]
    ds_read_b128 v[76:79], v15 offset:1920
    ds_read_b128 v[108:111], v16 offset:2432
    v_mfma_f32_16x16x32_bf16 v[36:39], v[136:139], v[164:167], v[36:39]
    ds_read_b128 v[80:83], v15 offset:2432
    ds_read_b128 v[112:115], v16 offset:1920
    v_mfma_f32_16x16x32_bf16 v[40:43], v[136:139], v[168:171], v[40:43]
    ds_read_b128 v[84:87], v15 offset:2944
    ds_read_b128 v[116:119], v16 offset:1408
    v_mfma_f32_16x16x32_bf16 v[36:39], v[128:131], v[172:175], v[36:39]
    s_add_u32 s36, s15, 458752
    s_add_u32 m0, s20, 28672
    s_nop 0
    buffer_load_dwordx4 v240, s[52:55], s36 offen lds
    v_mfma_f32_16x16x32_bf16 v[40:43], v[132:135], v[172:175], v[40:43]
    v_mfma_f32_16x16x32_bf16 v[44:47], v[136:139], v[172:175], v[44:47]
    v_mfma_f32_16x16x32_bf16 v[36:39], v[140:143], v[160:163], v[36:39]
    v_mfma_f32_16x16x32_bf16 v[40:43], v[140:143], v[164:167], v[40:43]
    v_mfma_f32_16x16x32_bf16 v[44:47], v[140:143], v[168:171], v[44:47]
    v_mfma_f32_16x16x32_bf16 v[40:43], v[128:131], v[176:179], v[40:43]
    s_add_u32 m0, s20, 29696
    s_nop 0
    buffer_load_dwordx4 v241, s[52:55], s36 offen lds
    v_mfma_f32_16x16x32_bf16 v[44:47], v[132:135], v[176:179], v[44:47]
    v_mfma_f32_16x16x32_bf16 v[40:43], v[144:147], v[160:163], v[40:43]
    v_mfma_f32_16x16x32_bf16 v[44:47], v[144:147], v[164:167], v[44:47]
    v_mfma_f32_16x16x32_bf16 v[44:47], v[128:131], v[180:183], v[44:47]
    v_mfma_f32_16x16x32_bf16 v[44:47], v[148:151], v[160:163], v[44:47]
    s_waitcnt lgkmcnt(0)
    v_mfma_f32_16x16x32_bf16 v[32:35], v[68:71], v[100:103], v[32:35]
    ds_read_b128 v[128:131], v15 offset:448
    ds_read_b128 v[160:163], v16 offset:4032
    v_mfma_f32_16x16x32_bf16 v[32:35], v[64:67], v[104:107], v[32:35]
    ds_read_b128 v[132:135], v15 offset:960
    ds_read_b128 v[164:167], v16 offset:3520
    v_mfma_f32_16x16x32_bf16 v[36:39], v[68:71], v[104:107], v[36:39]
    ds_read_b128 v[136:139], v15 offset:1472
    ds_read_b128 v[168:171], v16 offset:3008
    v_mfma_f32_16x16x32_bf16 v[32:35], v[72:75], v[96:99], v[32:35]
    ds_read_b128 v[140:143], v15 offset:1984
    ds_read_b128 v[172:175], v16 offset:2496
    v_mfma_f32_16x16x32_bf16 v[36:39], v[72:75], v[100:103], v[36:39]
    ds_read_b128 v[144:147], v15 offset:2496
    ds_read_b128 v[176:179], v16 offset:1984
    v_mfma_f32_16x16x32_bf16 v[40:43], v[72:75], v[104:107], v[40:43]
    ds_read_b128 v[148:151], v15 offset:3008
    ds_read_b128 v[180:183], v16 offset:1472
    v_mfma_f32_16x16x32_bf16 v[36:39], v[64:67], v[108:111], v[36:39]
    s_add_u32 m0, s20, 30720
    s_nop 0
    buffer_load_dwordx4 v242, s[52:55], s36 offen lds
    v_mfma_f32_16x16x32_bf16 v[40:43], v[68:71], v[108:111], v[40:43]
    v_mfma_f32_16x16x32_bf16 v[44:47], v[72:75], v[108:111], v[44:47]
    v_mfma_f32_16x16x32_bf16 v[36:39], v[76:79], v[96:99], v[36:39]
    v_mfma_f32_16x16x32_bf16 v[40:43], v[76:79], v[100:103], v[40:43]
    ds_read_b64 v[56:57], v20 offset:512
    v_mfma_f32_16x16x32_bf16 v[44:47], v[76:79], v[104:107], v[44:47]
    ds_read_b64 v[58:59], v20 offset:0
    v_mfma_f32_16x16x32_bf16 v[40:43], v[64:67], v[112:115], v[40:43]
    ds_read_b64 v[60:61], v21 offset:512
    s_add_u32 m0, s20, 31744
    s_nop 0
    buffer_load_dwordx4 v243, s[52:55], s36 offen lds
    v_mfma_f32_16x16x32_bf16 v[44:47], v[68:71], v[112:115], v[44:47]
    ds_read_b64 v[62:63], v21 offset:0
    v_mfma_f32_16x16x32_bf16 v[40:43], v[80:83], v[96:99], v[40:43]
    v_mfma_f32_16x16x32_bf16 v[44:47], v[80:83], v[100:103], v[44:47]
    v_mfma_f32_16x16x32_bf16 v[44:47], v[64:67], v[116:119], v[44:47]
    v_mfma_f32_16x16x32_bf16 v[44:47], v[84:87], v[96:99], v[44:47]
    s_waitcnt lgkmcnt(0)
    v_mfma_f32_16x16x32_bf16 v[32:35], v[132:135], v[164:167], v[32:35]
    s_waitcnt vmcnt(5)
    v_lshlrev_b32 v64, 16, v48
    v_and_b32 v65, 0xffff0000, v48
    v_mfma_f32_16x16x32_bf16 v[32:35], v[128:131], v[168:171], v[32:35]
    v_lshlrev_b32 v66, 16, v49
    v_and_b32 v67, 0xffff0000, v49
    v_lshlrev_b32 v73, 16, v57
    v_mfma_f32_16x16x32_bf16 v[36:39], v[132:135], v[168:171], v[36:39]
    v_and_b32 v72, 0xffff0000, v57
    v_lshlrev_b32 v75, 16, v56
    v_and_b32 v74, 0xffff0000, v56
    v_mfma_f32_16x16x32_bf16 v[32:35], v[136:139], v[160:163], v[32:35]
    v_fma_f32 v68, v64, v192, v196
    v_fma_f32 v69, v65, v193, v197
    v_fma_f32 v70, v66, v194, v198
    v_mfma_f32_16x16x32_bf16 v[36:39], v[136:139], v[164:167], v[36:39]
    v_fma_f32 v71, v67, v195, v199
    v_lshlrev_b32 v80, 16, v50
    v_and_b32 v81, 0xffff0000, v50
    v_mfma_f32_16x16x32_bf16 v[40:43], v[136:139], v[168:171], v[40:43]
    v_lshlrev_b32 v82, 16, v51
    v_and_b32 v83, 0xffff0000, v51
    v_lshlrev_b32 v89, 16, v59
    v_mfma_f32_16x16x32_bf16 v[36:39], v[128:131], v[172:175], v[36:39]
    v_and_b32 v88, 0xffff0000, v59
    v_lshlrev_b32 v91, 16, v58
    v_and_b32 v90, 0xffff0000, v58
    v_mfma_f32_16x16x32_bf16 v[40:43], v[132:135], v[172:175], v[40:43]
    v_fma_f32 v84, v80, v200, v204
    v_fma_f32 v85, v81, v201, v205
    v_fma_f32 v86, v82, v202, v206
    v_mfma_f32_16x16x32_bf16 v[44:47], v[136:139], v[172:175], v[44:47]
    v_fma_f32 v87, v83, v203, v207
    v_lshlrev_b32 v96, 16, v52
    v_and_b32 v97, 0xffff0000, v52
    v_mfma_f32_16x16x32_bf16 v[36:39], v[140:143], v[160:163], v[36:39]
    v_lshlrev_b32 v98, 16, v53
    v_and_b32 v99, 0xffff0000, v53
    v_lshlrev_b32 v105, 16, v61
    v_mfma_f32_16x16x32_bf16 v[40:43], v[140:143], v[164:167], v[40:43]
    v_and_b32 v104, 0xffff0000, v61
    v_lshlrev_b32 v107, 16, v60
    v_and_b32 v106, 0xffff0000, v60
    v_mfma_f32_16x16x32_bf16 v[44:47], v[140:143], v[168:171], v[44:47]
    v_fma_f32 v100, v96, v208, v212
    v_fma_f32 v101, v97, v209, v213
    v_fma_f32 v102, v98, v210, v214
    v_mfma_f32_16x16x32_bf16 v[40:43], v[128:131], v[176:179], v[40:43]
    v_fma_f32 v103, v99, v211, v215
    v_lshlrev_b32 v112, 16, v54
    v_and_b32 v113, 0xffff0000, v54
    s_add_u32 m0, s20, 32768
    s_nop 0
    buffer_load_dwordx4 v244, s[52:55], s36 offen lds
    v_mfma_f32_16x16x32_bf16 v[44:47], v[132:135], v[176:179], v[44:47]
    v_lshlrev_b32 v114, 16, v55
    v_and_b32 v115, 0xffff0000, v55
    v_lshlrev_b32 v121, 16, v63
    v_mfma_f32_16x16x32_bf16 v[40:43], v[144:147], v[160:163], v[40:43]
    v_and_b32 v120, 0xffff0000, v63
    v_lshlrev_b32 v123, 16, v62
    v_and_b32 v122, 0xffff0000, v62
    s_add_u32 m0, s20, 33792
    s_nop 0
    buffer_load_dwordx4 v245, s[52:55], s36 offen lds
    v_mfma_f32_16x16x32_bf16 v[44:47], v[144:147], v[164:167], v[44:47]
    v_fma_f32 v116, v112, v216, v220
    v_fma_f32 v117, v113, v217, v221
    v_fma_f32 v118, v114, v218, v222
    v_mfma_f32_16x16x32_bf16 v[44:47], v[128:131], v[180:183], v[44:47]
    v_fma_f32 v119, v115, v219, v223
    s_add_u32 m0, s20, 34816
    s_nop 0
    buffer_load_dwordx4 v246, s[52:55], s36 offen lds
    v_mfma_f32_16x16x32_bf16 v[44:47], v[148:151], v[160:163], v[44:47]
    s_branch L_CONVDONE
L_ROLEA:
    s_mul_i32 s4, s2, 7168
    s_and_b32 s5, s3, 1
    s_mul_i32 s5, s5, 3584
    s_add_u32 s4, s4, s5
    v_lshlrev_b32 v29, 7, v1
    v_cmp_lt_u32 vcc, 13, v1
    v_add_u32 v30, 1792, v29
    s_nop 0
    v_cndmask_b32 v30, v29, v30, vcc
    s_lshr_b32 s36, s68, 1
    s_lshl_b32 s36, s36, 6
    s_lshl_b32 s37, s69, 1
    s_add_u32 s36, s36, s37
    s_and_b32 s37, s3, 1
    s_add_u32 s36, s36, s37
    s_mul_i32 s36, s36, 7168
    s_and_b32 s37, s68, 1
    s_mul_i32 s37, s37, 1792
    s_add_u32 s36, s36, s37
    s_mov_b64 exec, 0xfffffff
    buffer_load_dword v253, v30, s[52:55], s36 offen
    buffer_load_dword v254, v29, s[56:59], s4 offen
    s_mov_b64 exec, -1
    ds_write_b128 v24, v[82:85] offset:13408
    ds_write_b128 v24, v[84:87] offset:30944
    v_alignbit_b32 v196, v81, v80, 16
    v_alignbit_b32 v197, v82, v81, 16
    v_alignbit_b32 v198, v83, v82, 16
    v_alignbit_b32 v199, v84, v83, 16
    v_alignbit_b32 v200, v85, v84, 16
    v_alignbit_b32 v201, v86, v85, 16
    v_alignbit_b32 v202, v82, v81, 16
    v_alignbit_b32 v203, v83, v82, 16
    v_alignbit_b32 v204, v84, v83, 16
    v_alignbit_b32 v205, v85, v84, 16
    v_alignbit_b32 v206, v86, v85, 16
    v_alignbit_b32 v207, v87, v86, 16
    v_mov_b32 v208, v81
    v_mov_b32 v209, v82
    v_mov_b32 v210, v83
    v_mov_b32 v211, v84
    v_mov_b32 v212, v85
    v_mov_b32 v213, v86
    ds_write_b128 v24, v[196:199] offset:256
    ds_write_b128 v24, v[198:201] offset:17792
    ds_write_b128 v24, v[202:205] offset:9024
    ds_write_b128 v24, v[204:207] offset:26560
    ds_write_b128 v24, v[208:211] offset:4640
    ds_write_b128 v24, v[210:213] offset:22176
    ds_write_b128 v24, v[90:93] offset:14432
    ds_write_b128 v24, v[92:95] offset:31968
    v_alignbit_b32 v214, v89, v88, 16
    v_alignbit_b32 v215, v90, v89, 16
    v_alignbit_b32 v216, v91, v90, 16
    v_alignbit_b32 v217, v92, v91, 16
    v_alignbit_b32 v218, v93, v92, 16
    v_alignbit_b32 v219, v94, v93, 16
    v_alignbit_b32 v220, v90, v89, 16
    v_alignbit_b32 v221, v91, v90, 16
    v_alignbit_b32 v222, v92, v91, 16
    v_alignbit_b32 v223, v93, v92, 16
    v_alignbit_b32 v224, v94, v93, 16
    v_alignbit_b32 v225, v95, v94, 16
    v_mov_b32 v226, v89
    v_mov_b32 v227, v90
    v_mov_b32 v228, v91
    v_mov_b32 v229, v92
    v_mov_b32 v230, v93
    v_mov_b32 v231, v94
    ds_write_b128 v24, v[214:217] offset:1280
    ds_write_b128 v24, v[216:219] offset:18816
    ds_write_b128 v24, v[220:223] offset:10048
    ds_write_b128 v24, v[222:225] offset:27584
    ds_write_b128 v24, v[226:229] offset:5664
    ds_write_b128 v24, v[228:231] offset:23200
    s_waitcnt vmcnt(2)
    s_mov_b64 exec, 1
    ds_add_rtn_u32 v249, v248, v249
    s_waitcnt lgkmcnt(0)
    v_cmp_ne_u32 vcc, 3, v249
    s_nop 0
    s_cmp_eq_u64 vcc, 0
    s_cselect_b32 s35, s35, 0x7ffffff0
    buffer_store_dword v250, v251, s[48:51], s35 offen sc1
    s_mov_b64 exec, -1
    s_waitcnt lgkmcnt(0)
    s_barrier
    ds_read_b128 v[64:67], v15 offset:0
    ds_read_b128 v[96:99], v16 offset:3584
    ds_read_b128 v[68:71], v15 offset:512
    ds_read_b128 v[100:103], v16 offset:3072
    ds_read_b128 v[72:75], v15 offset:1024
    ds_read_b128 v[104:107], v16 offset:2560
    ds_read_b128 v[76:79], v15 offset:1536
    ds_read_b128 v[108:111], v16 offset:2048
    ds_read_b128 v[80:83], v15 offset:2048
    ds_read_b128 v[112:115], v16 offset:1536
    ds_read_b128 v[84:87], v15 offset:2560
    ds_read_b128 v[116:119], v16 offset:1024
    ds_read_b128 v[88:91], v15 offset:3072
    ds_read_b128 v[120:123], v16 offset:512
    ds_read_b128 v[92:95], v15 offset:3584
    ds_read_b128 v[124:127], v16 offset:0
    buffer_load_dwordx4 v[224:227], v19, s[48:51], 0 offen sc1
    s_waitcnt lgkmcnt(14)
    v_mfma_f32_16x16x32_bf16 v[32:35], v[64:67], v[96:99], 0
    s_waitcnt lgkmcnt(12)
    v_mfma_f32_16x16x32_bf16 v[36:39], v[64:67], v[100:103], 0
    v_mfma_f32_16x16x32_bf16 v[36:39], v[68:71], v[96:99], v[36:39]
    s_waitcnt lgkmcnt(8)
    v_mfma_f32_16x16x32_bf16 v[40:43], v[76:79], v[108:111], 0
    s_waitcnt lgkmcnt(6)
    v_mfma_f32_16x16x32_bf16 v[40:43], v[72:75], v[112:115], v[40:43]
    ds_read_b128 v[128:131], v15 offset:64
    ds_read_b128 v[160:163], v16 offset:3648
    v_mfma_f32_16x16x32_bf16 v[44:47], v[76:79], v[112:115], 0
    ds_read_b128 v[132:135], v15 offset:576
    ds_read_b128 v[164:167], v16 offset:3136
    v_mfma_f32_16x16x32_bf16 v[40:43], v[80:83], v[104:107], v[40:43]
    ds_read_b128 v[136:139], v15 offset:1088
    ds_read_b128 v[168:171], v16 offset:2624
    v_mfma_f32_16x16x32_bf16 v[44:47], v[80:83], v[108:111], v[44:47]
    ds_read_b128 v[140:143], v15 offset:1600
    ds_read_b128 v[172:175], v16 offset:2112
    s_waitcnt lgkmcnt(12)
    v_mfma_f32_16x16x32_bf16 v[40:43], v[68:71], v[116:119], v[40:43]
    ds_read_b128 v[144:147], v15 offset:2112
    ds_read_b128 v[176:179], v16 offset:1600
    v_mfma_f32_16x16x32_bf16 v[44:47], v[72:75], v[116:119], v[44:47]
    ds_read_b128 v[148:151], v15 offset:2624
    ds_read_b128 v[180:183], v16 offset:1088
    v_mfma_f32_16x16x32_bf16 v[40:43], v[84:87], v[100:103], v[40:43]
    ds_read_b128 v[152:155], v15 offset:3136
    ds_read_b128 v[184:187], v16 offset:576
    v_mfma_f32_16x16x32_bf16 v[44:47], v[84:87], v[104:107], v[44:47]
    ds_read_b128 v[156:159], v15 offset:3648
    ds_read_b128 v[188:191], v16 offset:64
    s_waitcnt lgkmcnt(15)
    v_mfma_f32_16x16x32_bf16 v[40:43], v[64:67], v[120:123], v[40:43]
    s_add_u32 s36, s15, 0
    s_add_u32 m0, s20, 0
    s_nop 0
    buffer_load_dwordx4 v240, s[52:55], s36 offen lds
    v_mfma_f32_16x16x32_bf16 v[44:47], v[68:71], v[120:123], v[44:47]
    v_mfma_f32_16x16x32_bf16 v[40:43], v[88:91], v[96:99], v[40:43]
    v_mfma_f32_16x16x32_bf16 v[44:47], v[88:91], v[100:103], v[44:47]
    s_add_u32 m0, s20, 1024
    s_nop 0
    buffer_load_dwordx4 v241, s[52:55], s36 offen lds
    s_waitcnt lgkmcnt(15)
    v_mfma_f32_16x16x32_bf16 v[44:47], v[64:67], v[124:127], v[44:47]
    v_mfma_f32_16x16x32_bf16 v[44:47], v[92:95], v[96:99], v[44:47]
    s_waitcnt lgkmcnt(0)
    v_mfma_f32_16x16x32_bf16 v[32:35], v[128:131], v[160:163], v[32:35]
    ds_read_b128 v[64:67], v15 offset:128
    ds_read_b128 v[96:99], v16 offset:3712
    v_mfma_f32_16x16x32_bf16 v[36:39], v[128:131], v[164:167], v[36:39]
    ds_read_b128 v[68:71], v15 offset:640
    ds_read_b128 v[100:103], v16 offset:3200
    v_mfma_f32_16x16x32_bf16 v[36:39], v[132:135], v[160:163], v[36:39]
    ds_read_b128 v[72:75], v15 offset:1152
    ds_read_b128 v[104:107], v16 offset:2688
    v_mfma_f32_16x16x32_bf16 v[40:43], v[140:143], v[172:175], v[40:43]
    ds_read_b128 v[76:79], v15 offset:1664
    ds_read_b128 v[108:111], v16 offset:2176
    v_mfma_f32_16x16x32_bf16 v[40:43], v[136:139], v[176:179], v[40:43]
    ds_read_b128 v[80:83], v15 offset:2176
    ds_read_b128 v[112:115], v16 offset:1664
    v_mfma_f32_16x16x32_bf16 v[44:47], v[140:143], v[176:179], v[44:47]
    ds_read_b128 v[84:87], v15 offset:2688
    ds_read_b128 v[116:119], v16 offset:1152
    v_mfma_f32_16x16x32_bf16 v[40:43], v[144:147], v[168:171], v[40:43]
    ds_read_b128 v[88:91], v15 offset:3200
    ds_read_b128 v[120:123], v16 offset:640
    v_mfma_f32_16x16x32_bf16 v[44:47], v[144:147], v[172:175], v[44:47]
    ds_read_b128 v[92:95], v15 offset:3712
    ds_read_b128 v[124:127], v16 offset:128
    v_mfma_f32_16x16x32_bf16 v[40:43], v[132:135], v[180:183], v[40:43]
    s_add_u32 m0, s20, 2048
    s_nop 0
    buffer_load_dwordx4 v242, s[52:55], s36 offen lds
    v_mfma_f32_16x16x32_bf16 v[44:47], v[136:139], v[180:183], v[44:47]
    v_mfma_f32_16x16x32_bf16 v[40:43], v[148:151], v[164:167], v[40:43]
    v_mfma_f32_16x16x32_bf16 v[44:47], v[148:151], v[168:171], v[44:47]
    v_mfma_f32_16x16x32_bf16 v[40:43], v[128:131], v[184:187], v[40:43]
    v_mfma_f32_16x16x32_bf16 v[44:47], v[132:135], v[184:187], v[44:47]
    s_add_u32 m0, s20, 3072
    s_nop 0
    buffer_load_dwordx4 v243, s[52:55], s36 offen lds
    v_mfma_f32_16x16x32_bf16 v[40:43], v[152:155], v[160:163], v[40:43]
    v_mfma_f32_16x16x32_bf16 v[44:47], v[152:155], v[164:167], v[44:47]
    v_mfma_f32_16x16x32_bf16 v[44:47], v[128:131], v[188:191], v[44:47]
    v_mfma_f32_16x16x32_bf16 v[44:47], v[156:159], v[160:163], v[44:47]
    s_mov_b32 s19, 0
    s_waitcnt vmcnt(4)
    s_branch PCHK_9
POLL_7:
    s_mov_b64 exec, vcc
    buffer_load_dwordx4 v[224:227], v19, s[48:51], 0 offen sc1
    s_add_u32 s19, s19, 1
    s_waitcnt vmcnt(0)
PCHK_9:
    v_xor_b32 v224, s18, v224
    v_xor_b32 v225, s18, v225
    v_xor_b32 v226, s18, v226
    v_xor_b32 v227, s18, v227
    v_or3_b32 v224, v224, v225, v226
    v_or_b32 v224, v224, v227
    v_cmp_ne_u32 vcc, 0, v224
    s_cbranch_vccz PDONE_8
    s_cmp_lt_u32 s19, 65536
    s_cbranch_scc1 POLL_7
PDONE_8:
    s_mov_b64 exec, -1
    s_waitcnt lgkmcnt(0)
    v_mfma_f32_16x16x32_bf16 v[32:35], v[64:67], v[96:99], v[32:35]
    ds_read_b128 v[128:131], v15 offset:192
    ds_read_b128 v[160:163], v16 offset:3776
    v_mfma_f32_16x16x32_bf16 v[36:39], v[64:67], v[100:103], v[36:39]
    ds_read_b128 v[132:135], v15 offset:704
    ds_read_b128 v[164:167], v16 offset:3264
    v_mfma_f32_16x16x32_bf16 v[36:39], v[68:71], v[96:99], v[36:39]
    ds_read_b128 v[136:139], v15 offset:1216
    ds_read_b128 v[168:171], v16 offset:2752
    v_mfma_f32_16x16x32_bf16 v[40:43], v[76:79], v[108:111], v[40:43]
    ds_read_b128 v[140:143], v15 offset:1728
    ds_read_b128 v[172:175], v16 offset:2240
    v_mfma_f32_16x16x32_bf16 v[40:43], v[72:75], v[112:115], v[40:43]
    ds_read_b128 v[144:147], v15 offset:2240
    ds_read_b128 v[176:179], v16 offset:1728
    v_mfma_f32_16x16x32_bf16 v[44:47], v[76:79], v[112:115], v[44:47]
    ds_read_b128 v[148:151], v15 offset:2752
    ds_read_b128 v[180:183], v16 offset:1216
    v_mfma_f32_16x16x32_bf16 v[40:43], v[80:83], v[104:107], v[40:43]
    ds_read_b128 v[152:155], v15 offset:3264
    ds_read_b128 v[184:187], v16 offset:704
    v_mfma_f32_16x16x32_bf16 v[44:47], v[80:83], v[108:111], v[44:47]
    ds_read_b128 v[156:159], v15 offset:3776
    ds_read_b128 v[188:191], v16 offset:192
    v_mfma_f32_16x16x32_bf16 v[40:43], v[68:71], v[116:119], v[40:43]
    buffer_load_dwordx2 v[48:49], v17, s[48:51], s28 offen offset:0 sc1
    v_mfma_f32_16x16x32_bf16 v[44:47], v[72:75], v[116:119], v[44:47]
    v_mfma_f32_16x16x32_bf16 v[40:43], v[84:87], v[100:103], v[40:43]
    buffer_load_dwordx4 v[192:195], v18, s[48:51], s30 offen offset:0 sc1
    v_mfma_f32_16x16x32_bf16 v[44:47], v[84:87], v[104:107], v[44:47]
    v_mfma_f32_16x16x32_bf16 v[40:43], v[64:67], v[120:123], v[40:43]
    buffer_load_dwordx4 v[196:199], v236, s[48:51], s30 offen offset:0 sc1
    v_mfma_f32_16x16x32_bf16 v[44:47], v[68:71], v[120:123], v[44:47]
    v_mfma_f32_16x16x32_bf16 v[40:43], v[88:91], v[96:99], v[40:43]
    buffer_load_dwordx2 v[50:51], v17, s[48:51], s28 offen offset:512 sc1
    v_mfma_f32_16x16x32_bf16 v[44:47], v[88:91], v[100:103], v[44:47]
    v_mfma_f32_16x16x32_bf16 v[44:47], v[64:67], v[124:127], v[44:47]
    s_add_u32 m0, s20, 4096
    s_nop 0
    buffer_load_dwordx4 v244, s[52:55], s36 offen lds
    v_mfma_f32_16x16x32_bf16 v[44:47], v[92:95], v[96:99], v[44:47]
    s_waitcnt lgkmcnt(0)
    v_mfma_f32_16x16x32_bf16 v[32:35], v[128:131], v[160:163], v[32:35]
    ds_read_b128 v[64:67], v15 offset:256
    ds_read_b128 v[96:99], v16 offset:3840
    v_mfma_f32_16x16x32_bf16 v[36:39], v[128:131], v[164:167], v[36:39]
    ds_read_b128 v[68:71], v15 offset:768
    ds_read_b128 v[100:103], v16 offset:3328
    v_mfma_f32_16x16x32_bf16 v[36:39], v[132:135], v[160:163], v[36:39]
    ds_read_b128 v[72:75], v15 offset:1280
    ds_read_b128 v[104:107], v16 offset:2816
    v_mfma_f32_16x16x32_bf16 v[40:43], v[140:143], v[172:175], v[40:43]
    ds_read_b128 v[76:79], v15 offset:1792
    ds_read_b128 v[108:111], v16 offset:2304
    v_mfma_f32_16x16x32_bf16 v[40:43], v[136:139], v[176:179], v[40:43]
    ds_read_b128 v[80:83], v15 offset:2304
    ds_read_b128 v[112:115], v16 offset:1792
    v_mfma_f32_16x16x32_bf16 v[44:47], v[140:143], v[176:179], v[44:47]
    ds_read_b128 v[84:87], v15 offset:2816
    ds_read_b128 v[116:119], v16 offset:1280
    v_mfma_f32_16x16x32_bf16 v[40:43], v[144:147], v[168:171], v[40:43]
    ds_read_b128 v[88:91], v15 offset:3328
    ds_read_b128 v[120:123], v16 offset:768
    v_mfma_f32_16x16x32_bf16 v[44:47], v[144:147], v[172:175], v[44:47]
    ds_read_b128 v[92:95], v15 offset:3840
    ds_read_b128 v[124:127], v16 offset:256
    v_mfma_f32_16x16x32_bf16 v[40:43], v[132:135], v[180:183], v[40:43]
    buffer_load_dwordx4 v[200:203], v18, s[48:51], s30 offen offset:1024 sc1
    v_mfma_f32_16x16x32_bf16 v[44:47], v[136:139], v[180:183], v[44:47]
    v_mfma_f32_16x16x32_bf16 v[40:43], v[148:151], v[164:167], v[40:43]
    buffer_load_dwordx4 v[204:207], v236, s[48:51], s30 offen offset:1024 sc1
    v_mfma_f32_16x16x32_bf16 v[44:47], v[148:151], v[168:171], v[44:47]
    v_mfma_f32_16x16x32_bf16 v[40:43], v[128:131], v[184:187], v[40:43]
    buffer_load_dwordx2 v[52:53], v17, s[48:51], s29 offen offset:0 sc1
    v_mfma_f32_16x16x32_bf16 v[44:47], v[132:135], v[184:187], v[44:47]
    v_mfma_f32_16x16x32_bf16 v[40:43], v[152:155], v[160:163], v[40:43]
    buffer_load_dwordx4 v[208:211], v18, s[48:51], s31 offen offset:0 sc1
    v_mfma_f32_16x16x32_bf16 v[44:47], v[152:155], v[164:167], v[44:47]
    v_mfma_f32_16x16x32_bf16 v[44:47], v[128:131], v[188:191], v[44:47]
    s_add_u32 m0, s20, 5120
    s_nop 0
    buffer_load_dwordx4 v245, s[52:55], s36 offen lds
    v_mfma_f32_16x16x32_bf16 v[44:47], v[156:159], v[160:163], v[44:47]
    s_waitcnt lgkmcnt(0)
    v_mfma_f32_16x16x32_bf16 v[32:35], v[64:67], v[96:99], v[32:35]
    ds_read_b128 v[128:131], v15 offset:320
    ds_read_b128 v[160:163], v16 offset:3904
    v_mfma_f32_16x16x32_bf16 v[36:39], v[64:67], v[100:103], v[36:39]
    ds_read_b128 v[132:135], v15 offset:832
    ds_read_b128 v[164:167], v16 offset:3392
    v_mfma_f32_16x16x32_bf16 v[36:39], v[68:71], v[96:99], v[36:39]
    ds_read_b128 v[136:139], v15 offset:1344
    ds_read_b128 v[168:171], v16 offset:2880
    v_mfma_f32_16x16x32_bf16 v[40:43], v[76:79], v[108:111], v[40:43]
    ds_read_b128 v[140:143], v15 offset:1856
    ds_read_b128 v[172:175], v16 offset:2368
    v_mfma_f32_16x16x32_bf16 v[40:43], v[72:75], v[112:115], v[40:43]
    ds_read_b128 v[144:147], v15 offset:2368
    ds_read_b128 v[176:179], v16 offset:1856
    v_mfma_f32_16x16x32_bf16 v[44:47], v[76:79], v[112:115], v[44:47]
    ds_read_b128 v[148:151], v15 offset:2880
    ds_read_b128 v[180:183], v16 offset:1344
    v_mfma_f32_16x16x32_bf16 v[40:43], v[80:83], v[104:107], v[40:43]
    ds_read_b128 v[152:155], v15 offset:3392
    ds_read_b128 v[184:187], v16 offset:832
    v_mfma_f32_16x16x32_bf16 v[44:47], v[80:83], v[108:111], v[44:47]
    ds_read_b128 v[156:159], v15 offset:3904
    ds_read_b128 v[188:191], v16 offset:320
    v_mfma_f32_16x16x32_bf16 v[40:43], v[68:71], v[116:119], v[40:43]
    buffer_load_dwordx4 v[212:215], v236, s[48:51], s31 offen offset:0 sc1
    v_mfma_f32_16x16x32_bf16 v[44:47], v[72:75], v[116:119], v[44:47]
    v_mfma_f32_16x16x32_bf16 v[40:43], v[84:87], v[100:103], v[40:43]
    buffer_load_dwordx2 v[54:55], v17, s[48:51], s29 offen offset:512 sc1
    v_mfma_f32_16x16x32_bf16 v[44:47], v[84:87], v[104:107], v[44:47]
    v_mfma_f32_16x16x32_bf16 v[40:43], v[64:67], v[120:123], v[40:43]
    buffer_load_dwordx4 v[216:219], v18, s[48:51], s31 offen offset:1024 sc1
    v_mfma_f32_16x16x32_bf16 v[44:47], v[68:71], v[120:123], v[44:47]
    v_mfma_f32_16x16x32_bf16 v[40:43], v[88:91], v[96:99], v[40:43]
    buffer_load_dwordx4 v[220:223], v236, s[48:51], s31 offen offset:1024 sc1
    v_mfma_f32_16x16x32_bf16 v[44:47], v[88:91], v[100:103], v[44:47]
    v_mfma_f32_16x16x32_bf16 v[44:47], v[64:67], v[124:127], v[44:47]
    s_add_u32 m0, s20, 6144
    s_nop 0
    buffer_load_dwordx4 v246, s[52:55], s36 offen lds
    v_mfma_f32_16x16x32_bf16 v[44:47], v[92:95], v[96:99], v[44:47]
    s_waitcnt lgkmcnt(0)
    v_mfma_f32_16x16x32_bf16 v[32:35], v[128:131], v[160:163], v[32:35]
    ds_read_b128 v[64:67], v15 offset:384
    ds_read_b128 v[96:99], v16 offset:3968
    v_mfma_f32_16x16x32_bf16 v[36:39], v[128:131], v[164:167], v[36:39]
    ds_read_b128 v[68:71], v15 offset:896
    ds_read_b128 v[100:103], v16 offset:3456
    v_mfma_f32_16x16x32_bf16 v[36:39], v[132:135], v[160:163], v[36:39]
    ds_read_b128 v[72:75], v15 offset:1408
    ds_read_b128 v[104:107], v16 offset:2944
    v_mfma_f32_16x16x32_bf16 v[40:43], v[140:143], v[172:175], v[40:43]
    ds_read_b128 v[76:79], v15 offset:1920
    ds_read_b128 v[108:111], v16 offset:2432
    v_mfma_f32_16x16x32_bf16 v[40:43], v[136:139], v[176:179], v[40:43]
    ds_read_b128 v[80:83], v15 offset:2432
    ds_read_b128 v[112:115], v16 offset:1920
    v_mfma_f32_16x16x32_bf16 v[44:47], v[140:143], v[176:179], v[44:47]
    ds_read_b128 v[84:87], v15 offset:2944
    ds_read_b128 v[116:119], v16 offset:1408
    v_mfma_f32_16x16x32_bf16 v[40:43], v[144:147], v[168:171], v[40:43]
    ds_read_b128 v[88:91], v15 offset:3456
    ds_read_b128 v[120:123], v16 offset:896
    v_mfma_f32_16x16x32_bf16 v[44:47], v[144:147], v[172:175], v[44:47]
    ds_read_b128 v[92:95], v15 offset:3968
    ds_read_b128 v[124:127], v16 offset:384
    v_mfma_f32_16x16x32_bf16 v[40:43], v[132:135], v[180:183], v[40:43]
    s_add_u32 s36, s15, 458752
    s_add_u32 m0, s20, 28672
    s_nop 0
    buffer_load_dwordx4 v240, s[52:55], s36 offen lds
    v_mfma_f32_16x16x32_bf16 v[44:47], v[136:139], v[180:183], v[44:47]
    v_mfma_f32_16x16x32_bf16 v[40:43], v[148:151], v[164:167], v[40:43]
    v_mfma_f32_16x16x32_bf16 v[44:47], v[148:151], v[168:171], v[44:47]
    v_mfma_f32_16x16x32_bf16 v[40:43], v[128:131], v[184:187], v[40:43]
    v_mfma_f32_16x16x32_bf16 v[44:47], v[132:135], v[184:187], v[44:47]
    s_add_u32 m0, s20, 29696
    s_nop 0
    buffer_load_dwordx4 v241, s[52:55], s36 offen lds
    v_mfma_f32_16x16x32_bf16 v[40:43], v[152:155], v[160:163], v[40:43]
    v_mfma_f32_16x16x32_bf16 v[44:47], v[152:155], v[164:167], v[44:47]
    v_mfma_f32_16x16x32_bf16 v[44:47], v[128:131], v[188:191], v[44:47]
    v_mfma_f32_16x16x32_bf16 v[44:47], v[156:159], v[160:163], v[44:47]
    s_waitcnt lgkmcnt(0)
    v_mfma_f32_16x16x32_bf16 v[32:35], v[64:67], v[96:99], v[32:35]
    ds_read_b128 v[128:131], v15 offset:448
    ds_read_b128 v[160:163], v16 offset:4032
    v_mfma_f32_16x16x32_bf16 v[36:39], v[64:67], v[100:103], v[36:39]
    ds_read_b128 v[132:135], v15 offset:960
    ds_read_b128 v[164:167], v16 offset:3520
    v_mfma_f32_16x16x32_bf16 v[36:39], v[68:71], v[96:99], v[36:39]
    ds_read_b128 v[136:139], v15 offset:1472
    ds_read_b128 v[168:171], v16 offset:3008
    v_mfma_f32_16x16x32_bf16 v[40:43], v[76:79], v[108:111], v[40:43]
    ds_read_b128 v[140:143], v15 offset:1984
    ds_read_b128 v[172:175], v16 offset:2496
    v_mfma_f32_16x16x32_bf16 v[40:43], v[72:75], v[112:115], v[40:43]
    ds_read_b128 v[144:147], v15 offset:2496
    ds_read_b128 v[176:179], v16 offset:1984
    v_mfma_f32_16x16x32_bf16 v[44:47], v[76:79], v[112:115], v[44:47]
    ds_read_b128 v[148:151], v15 offset:3008
    ds_read_b128 v[180:183], v16 offset:1472
    v_mfma_f32_16x16x32_bf16 v[40:43], v[80:83], v[104:107], v[40:43]
    ds_read_b128 v[152:155], v15 offset:3520
    ds_read_b128 v[184:187], v16 offset:960
    v_mfma_f32_16x16x32_bf16 v[44:47], v[80:83], v[108:111], v[44:47]
    ds_read_b128 v[156:159], v15 offset:4032
    ds_read_b128 v[188:191], v16 offset:448
    v_mfma_f32_16x16x32_bf16 v[40:43], v[68:71], v[116:119], v[40:43]
    s_add_u32 m0, s20, 30720
    s_nop 0
    buffer_load_dwordx4 v242, s[52:55], s36 offen lds
    v_mfma_f32_16x16x32_bf16 v[44:47], v[72:75], v[116:119], v[44:47]
    v_mfma_f32_16x16x32_bf16 v[40:43], v[84:87], v[100:103], v[40:43]
    ds_read_b64 v[56:57], v20 offset:512
    v_mfma_f32_16x16x32_bf16 v[44:47], v[84:87], v[104:107], v[44:47]
    ds_read_b64 v[58:59], v20 offset:0
    v_mfma_f32_16x16x32_bf16 v[40:43], v[64:67], v[120:123], v[40:43]
    ds_read_b64 v[60:61], v21 offset:512
    v_mfma_f32_16x16x32_bf16 v[44:47], v[68:71], v[120:123], v[44:47]
    ds_read_b64 v[62:63], v21 offset:0
    s_add_u32 m0, s20, 31744
    s_nop 0
    buffer_load_dwordx4 v243, s[52:55], s36 offen lds
    v_mfma_f32_16x16x32_bf16 v[40:43], v[88:91], v[96:99], v[40:43]
    v_mfma_f32_16x16x32_bf16 v[44:47], v[88:91], v[100:103], v[44:47]
    v_mfma_f32_16x16x32_bf16 v[44:47], v[64:67], v[124:127], v[44:47]
    v_mfma_f32_16x16x32_bf16 v[44:47], v[92:95], v[96:99], v[44:47]
    s_waitcnt lgkmcnt(0)
    v_mfma_f32_16x16x32_bf16 v[32:35], v[128:131], v[160:163], v[32:35]
    s_waitcnt vmcnt(5)
    v_lshlrev_b32 v64, 16, v48
    v_and_b32 v65, 0xffff0000, v48
    v_mfma_f32_16x16x32_bf16 v[36:39], v[128:131], v[164:167], v[36:39]
    v_lshlrev_b32 v66, 16, v49
    v_and_b32 v67, 0xffff0000, v49
    v_lshlrev_b32 v73, 16, v57
    v_mfma_f32_16x16x32_bf16 v[36:39], v[132:135], v[160:163], v[36:39]
    v_and_b32 v72, 0xffff0000, v57
    v_lshlrev_b32 v75, 16, v56
    v_and_b32 v74, 0xffff0000, v56
    v_mfma_f32_16x16x32_bf16 v[40:43], v[140:143], v[172:175], v[40:43]
    v_fma_f32 v68, v64, v192, v196
    v_fma_f32 v69, v65, v193, v197
    v_fma_f32 v70, v66, v194, v198
    v_mfma_f32_16x16x32_bf16 v[40:43], v[136:139], v[176:179], v[40:43]
    v_fma_f32 v71, v67, v195, v199
    v_lshlrev_b32 v80, 16, v50
    v_and_b32 v81, 0xffff0000, v50
    v_mfma_f32_16x16x32_bf16 v[44:47], v[140:143], v[176:179], v[44:47]
    v_lshlrev_b32 v82, 16, v51
    v_and_b32 v83, 0xffff0000, v51
    v_lshlrev_b32 v89, 16, v59
    v_mfma_f32_16x16x32_bf16 v[40:43], v[144:147], v[168:171], v[40:43]
    v_and_b32 v88, 0xffff0000, v59
    v_lshlrev_b32 v91, 16, v58
    v_and_b32 v90, 0xffff0000, v58
    v_mfma_f32_16x16x32_bf16 v[44:47], v[144:147], v[172:175], v[44:47]
    v_fma_f32 v84, v80, v200, v204
    v_fma_f32 v85, v81, v201, v205
    v_fma_f32 v86, v82, v202, v206
    v_mfma_f32_16x16x32_bf16 v[40:43], v[132:135], v[180:183], v[40:43]
    v_fma_f32 v87, v83, v203, v207
    v_lshlrev_b32 v96, 16, v52
    v_and_b32 v97, 0xffff0000, v52
    v_mfma_f32_16x16x32_bf16 v[44:47], v[136:139], v[180:183], v[44:47]
    v_lshlrev_b32 v98, 16, v53
    v_and_b32 v99, 0xffff0000, v53
    v_lshlrev_b32 v105, 16, v61
    v_mfma_f32_16x16x32_bf16 v[40:43], v[148:151], v[164:167], v[40:43]
    v_and_b32 v104, 0xffff0000, v61
    v_lshlrev_b32 v107, 16, v60
    v_and_b32 v106, 0xffff0000, v60
    v_mfma_f32_16x16x32_bf16 v[44:47], v[148:151], v[168:171], v[44:47]
    v_fma_f32 v100, v96, v208, v212
    v_fma_f32 v101, v97, v209, v213
    v_fma_f32 v102, v98, v210, v214
    v_mfma_f32_16x16x32_bf16 v[40:43], v[128:131], v[184:187], v[40:43]
    v_fma_f32 v103, v99, v211, v215
    v_lshlrev_b32 v112, 16, v54
    v_and_b32 v113, 0xffff0000, v54
    s_add_u32 m0, s20, 32768
    s_nop 0
    buffer_load_dwordx4 v244, s[52:55], s36 offen lds
    v_mfma_f32_16x16x32_bf16 v[44:47], v[132:135], v[184:187], v[44:47]
    v_lshlrev_b32 v114, 16, v55
    v_and_b32 v115, 0xffff0000, v55
    v_lshlrev_b32 v121, 16, v63
    v_mfma_f32_16x16x32_bf16 v[40:43], v[152:155], v[160:163], v[40:43]
    v_and_b32 v120, 0xffff0000, v63
    v_lshlrev_b32 v123, 16, v62
    v_and_b32 v122, 0xffff0000, v62
    s_add_u32 m0, s20, 33792
    s_nop 0
    buffer_load_dwordx4 v245, s[52:55], s36 offen lds
    v_mfma_f32_16x16x32_bf16 v[44:47], v[152:155], v[164:167], v[44:47]
    v_fma_f32 v116, v112, v216, v220
    v_fma_f32 v117, v113, v217, v221
    v_fma_f32 v118, v114, v218, v222
    v_mfma_f32_16x16x32_bf16 v[44:47], v[128:131], v[188:191], v[44:47]
    v_fma_f32 v119, v115, v219, v223
    s_add_u32 m0, s20, 34816
    s_nop 0
    buffer_load_dwordx4 v246, s[52:55], s36 offen lds
    v_mfma_f32_16x16x32_bf16 v[44:47], v[156:159], v[160:163], v[44:47]
L_CONVDONE:
    v_pk_fma_f32 v[32:33], v[72:73], s[26:27], v[32:33]
    v_pk_fma_f32 v[34:35], v[74:75], s[26:27], v[34:35]
    v_pk_fma_f32 v[68:69], v[68:69], v[32:33], v[64:65]
    v_pk_fma_f32 v[70:71], v[70:71], v[34:35], v[66:67]
    v_cvt_pk_bf16_f32 v128, v68, v69
    v_cvt_pk_bf16_f32 v129, v70, v71
    v_pk_fma_f32 v[36:37], v[88:89], s[26:27], v[36:37]
    v_pk_fma_f32 v[38:39], v[90:91], s[26:27], v[38:39]
    v_pk_fma_f32 v[84:85], v[84:85], v[36:37], v[80:81]
    v_pk_fma_f32 v[86:87], v[86:87], v[38:39], v[82:83]
    v_cvt_pk_bf16_f32 v130, v84, v85
    v_cvt_pk_bf16_f32 v131, v86, v87
    s_nop 0
    v_permlane16_swap_b32 v128, v130
    v_permlane16_swap_b32 v129, v131
    buffer_store_dwordx4 v[128:131], v22, s[48:51], s32 offen sc1
    v_pk_fma_f32 v[40:41], v[104:105], s[26:27], v[40:41]
    v_pk_fma_f32 v[42:43], v[106:107], s[26:27], v[42:43]
    v_pk_fma_f32 v[100:101], v[100:101], v[40:41], v[96:97]
    v_pk_fma_f32 v[102:103], v[102:103], v[42:43], v[98:99]
    v_cvt_pk_bf16_f32 v132, v100, v101
    v_cvt_pk_bf16_f32 v133, v102, v103
    v_pk_fma_f32 v[44:45], v[120:121], s[26:27], v[44:45]
    v_pk_fma_f32 v[46:47], v[122:123], s[26:27], v[46:47]
    v_pk_fma_f32 v[116:117], v[116:117], v[44:45], v[112:113]
    v_pk_fma_f32 v[118:119], v[118:119], v[46:47], v[114:115]
    v_cvt_pk_bf16_f32 v134, v116, v117
    v_cvt_pk_bf16_f32 v135, v118, v119
    s_nop 0
    v_permlane16_swap_b32 v132, v134
    v_permlane16_swap_b32 v133, v135
    buffer_store_dwordx4 v[132:135], v22, s[48:51], s33 offen sc1
    v_lshrrev_b32 v13, 2, v1
    v_and_b32 v15, 3, v1
    s_movk_i32 s4, 224
    v_mul_u32_u24 v8, s4, v13
    v_lshl_add_u32 v8, v15, 3, v8
    v_add_u32 v9, 57344, v8
    v_lshlrev_b32 v10, 6, v13
    v_lshl_add_u32 v10, v15, 3, v10
    v_bfe_u32 v15, v1, 4, 1
    v_lshlrev_b32 v15, 5, v15
    v_xor_b32 v10, v10, v15
    v_add_u32 v10, s21, v10
    v_xor_b32 v11, 32, v10
    v_xor_b32 v12, v5, v15
    v_mov_b32 v136, 0x3f803f80
    v_mov_b32 v137, 0x3f803f80
    v_mov_b32 v138, 0x3f803f80
    v_mov_b32 v139, 0x3f803f80
    v_add_u32 v13, s20, v8
    v_add_u32 v14, s20, v9
    v_and_b32 v16, 15, v1
    s_lshl_b32 s4, s3, 4
    v_add_lshl_u32 v16, v16, s4, 7
    v_add_u32 v16, 131072, v16
    s_and_b32 s37, s2, 63
    s_lshl_b32 s37, s37, 7
    s_lshr_b32 s38, s2, 6
    s_lshl_b32 s38, s38, 2
    s_add_u32 s37, s37, s38
    s_add_u32 s37, s37, 131072
    s_cmp_eq_u32 s3, 0
    s_cselect_b32 s37, s37, 0x7ffffff0
    v_and_b32 v17, 48, v1
    v_add_u32 v17, 124928, v17
    s_mul_i32 s4, s3, 448
    v_add_u32 v18, s4, v17
    s_waitcnt vmcnt(2)
    ds_read_b64_tr_b16 v[140:141], v13 offset:0
    ds_read_b64_tr_b16 v[142:143], v13 offset:3584
    ds_read_b64_tr_b16 v[144:145], v13 offset:32
    ds_read_b64_tr_b16 v[146:147], v13 offset:3616
    ds_read_b64_tr_b16 v[148:149], v13 offset:64
    ds_read_b64_tr_b16 v[150:151], v13 offset:3648
    ds_read_b64_tr_b16 v[152:153], v13 offset:96
    ds_read_b64_tr_b16 v[154:155], v13 offset:3680
    ds_read_b64_tr_b16 v[156:157], v13 offset:128
    ds_read_b64_tr_b16 v[158:159], v13 offset:3712
    ds_read_b64_tr_b16 v[160:161], v13 offset:160
    ds_read_b64_tr_b16 v[162:163], v13 offset:3744
    ds_read_b64_tr_b16 v[164:165], v13 offset:192
    ds_read_b64_tr_b16 v[166:167], v13 offset:3776
    ds_read_b64_tr_b16 v[176:177], v13 offset:28672
    ds_read_b64_tr_b16 v[178:179], v13 offset:32256
    ds_read_b64_tr_b16 v[180:181], v13 offset:28704
    ds_read_b64_tr_b16 v[182:183], v13 offset:32288
    ds_read_b64_tr_b16 v[184:185], v13 offset:28736
    ds_read_b64_tr_b16 v[186:187], v13 offset:32320
    ds_read_b64_tr_b16 v[188:189], v13 offset:28768
    ds_read_b64_tr_b16 v[190:191], v13 offset:32352
    ds_read_b64_tr_b16 v[192:193], v13 offset:28800
    ds_read_b64_tr_b16 v[194:195], v13 offset:32384
    ds_read_b64_tr_b16 v[196:197], v13 offset:28832
    ds_read_b64_tr_b16 v[198:199], v13 offset:32416
    ds_read_b64_tr_b16 v[200:201], v13 offset:28864
    ds_read_b64_tr_b16 v[202:203], v13 offset:32448
    s_waitcnt lgkmcnt(14)
    v_mfma_f32_16x16x32_bf16 v[212:215], v[140:143], v[136:139], 0
    v_mfma_f32_16x16x32_bf16 v[216:219], v[144:147], v[136:139], 0
    v_mfma_f32_16x16x32_bf16 v[220:223], v[148:151], v[136:139], 0
    v_mfma_f32_16x16x32_bf16 v[224:227], v[152:155], v[136:139], 0
    v_mfma_f32_16x16x32_bf16 v[228:231], v[156:159], v[136:139], 0
    v_mfma_f32_16x16x32_bf16 v[232:235], v[160:163], v[136:139], 0
    v_mfma_f32_16x16x32_bf16 v[236:239], v[164:167], v[136:139], 0
    s_waitcnt lgkmcnt(0)
    v_mfma_f32_16x16x32_bf16 v[212:215], v[176:179], v[136:139], v[212:215]
    v_mfma_f32_16x16x32_bf16 v[216:219], v[180:183], v[136:139], v[216:219]
    v_mfma_f32_16x16x32_bf16 v[220:223], v[184:187], v[136:139], v[220:223]
    v_mfma_f32_16x16x32_bf16 v[224:227], v[188:191], v[136:139], v[224:227]
    v_mfma_f32_16x16x32_bf16 v[228:231], v[192:195], v[136:139], v[228:231]
    v_mfma_f32_16x16x32_bf16 v[232:235], v[196:199], v[136:139], v[232:235]
    v_mfma_f32_16x16x32_bf16 v[236:239], v[200:203], v[136:139], v[236:239]
    s_waitcnt vmcnt(0)
    s_barrier
    s_mov_b64 exec, 1
    buffer_store_dword v250, v251, s[48:51], s37 offen sc1
    s_mov_b64 exec, -1
    s_add_u32 s36, s15, 917504
    s_add_u32 m0, s20, 57344
    s_nop 0
    buffer_load_dwordx4 v240, s[52:55], s36 offen lds
    s_add_u32 m0, s20, 58368
    s_nop 0
    buffer_load_dwordx4 v241, s[52:55], s36 offen lds
    s_add_u32 m0, s20, 59392
    s_nop 0
    buffer_load_dwordx4 v242, s[52:55], s36 offen lds
    s_add_u32 m0, s20, 60416
    s_nop 0
    buffer_load_dwordx4 v243, s[52:55], s36 offen lds
    s_add_u32 m0, s20, 61440
    s_nop 0
    buffer_load_dwordx4 v244, s[52:55], s36 offen lds
    s_add_u32 m0, s20, 62464
    s_nop 0
    buffer_load_dwordx4 v245, s[52:55], s36 offen lds
    s_add_u32 m0, s20, 63488
    s_nop 0
    buffer_load_dwordx4 v246, s[52:55], s36 offen lds
    s_add_u32 s36, s15, 1376256
    s_add_u32 m0, s20, 86016
    s_nop 0
    buffer_load_dwordx4 v240, s[52:55], s36 offen lds
    s_add_u32 m0, s20, 87040
    s_nop 0
    buffer_load_dwordx4 v241, s[52:55], s36 offen lds
    s_add_u32 m0, s20, 88064
    s_nop 0
    buffer_load_dwordx4 v242, s[52:55], s36 offen lds
    s_add_u32 m0, s20, 89088
    s_nop 0
    buffer_load_dwordx4 v243, s[52:55], s36 offen lds
    s_add_u32 m0, s20, 90112
    s_nop 0
    buffer_load_dwordx4 v244, s[52:55], s36 offen lds
    s_add_u32 m0, s20, 91136
    s_nop 0
    buffer_load_dwordx4 v245, s[52:55], s36 offen lds
    s_add_u32 m0, s20, 92160
    s_nop 0
    buffer_load_dwordx4 v246, s[52:55], s36 offen lds
    s_waitcnt vmcnt(7)
    s_add_u32 m0, s21, 0
    s_add_u32 s13, s13, 8192
    buffer_load_dwordx4 v25, s[56:59], s13 offen lds
    s_add_u32 m0, s21, 1024
    s_add_u32 s13, s13, 8192
    buffer_load_dwordx4 v25, s[56:59], s13 offen lds
    s_add_u32 m0, s21, 2048
    s_add_u32 s13, s13, 8192
    buffer_load_dwordx4 v25, s[56:59], s13 offen lds
    ds_read_b64_tr_b16 v[140:141], v14 offset:0
    ds_read_b64_tr_b16 v[142:143], v14 offset:3584
    ds_read_b64_tr_b16 v[144:145], v14 offset:32
    ds_read_b64_tr_b16 v[146:147], v14 offset:3616
    ds_read_b64_tr_b16 v[148:149], v14 offset:64
    ds_read_b64_tr_b16 v[150:151], v14 offset:3648
    ds_read_b64_tr_b16 v[152:153], v14 offset:96
    ds_read_b64_tr_b16 v[154:155], v14 offset:3680
    ds_read_b64_tr_b16 v[156:157], v14 offset:128
    ds_read_b64_tr_b16 v[158:159], v14 offset:3712
    ds_read_b64_tr_b16 v[160:161], v14 offset:160
    ds_read_b64_tr_b16 v[162:163], v14 offset:3744
    ds_read_b64_tr_b16 v[164:165], v14 offset:192
    ds_read_b64_tr_b16 v[166:167], v14 offset:3776
    s_waitcnt lgkmcnt(0)
    v_mfma_f32_16x16x32_bf16 v[212:215], v[140:143], v[136:139], v[212:215]
    v_mfma_f32_16x16x32_bf16 v[216:219], v[144:147], v[136:139], v[216:219]
    v_mfma_f32_16x16x32_bf16 v[220:223], v[148:151], v[136:139], v[220:223]
    v_mfma_f32_16x16x32_bf16 v[224:227], v[152:155], v[136:139], v[224:227]
    v_mfma_f32_16x16x32_bf16 v[228:231], v[156:159], v[136:139], v[228:231]
    v_mfma_f32_16x16x32_bf16 v[232:235], v[160:163], v[136:139], v[232:235]
    v_mfma_f32_16x16x32_bf16 v[236:239], v[164:167], v[136:139], v[236:239]
    s_waitcnt vmcnt(3)
    s_add_u32 m0, s21, 3072
    s_add_u32 s13, s13, 8192
    buffer_load_dwordx4 v25, s[56:59], s13 offen lds
    s_add_u32 m0, s21, 4096
    s_add_u32 s13, s13, 8192
    buffer_load_dwordx4 v25, s[56:59], s13 offen lds
    s_add_u32 m0, s21, 5120
    s_add_u32 s13, s13, 8192
    buffer_load_dwordx4 v25, s[56:59], s13 offen lds
    buffer_load_dwordx4 v[32:35], v16, s[48:51], 0 offen sc1
    ds_read_b64_tr_b16 v[140:141], v14 offset:28672
    ds_read_b64_tr_b16 v[142:143], v14 offset:32256
    ds_read_b64_tr_b16 v[144:145], v14 offset:28704
    ds_read_b64_tr_b16 v[146:147], v14 offset:32288
    ds_read_b64_tr_b16 v[148:149], v14 offset:28736
    ds_read_b64_tr_b16 v[150:151], v14 offset:32320
    ds_read_b64_tr_b16 v[152:153], v14 offset:28768
    ds_read_b64_tr_b16 v[154:155], v14 offset:32352
    ds_read_b64_tr_b16 v[156:157], v14 offset:28800
    ds_read_b64_tr_b16 v[158:159], v14 offset:32384
    ds_read_b64_tr_b16 v[160:161], v14 offset:28832
    ds_read_b64_tr_b16 v[162:163], v14 offset:32416
    ds_read_b64_tr_b16 v[164:165], v14 offset:28864
    ds_read_b64_tr_b16 v[166:167], v14 offset:32448
    s_waitcnt lgkmcnt(0)
    v_mfma_f32_16x16x32_bf16 v[212:215], v[140:143], v[136:139], v[212:215]
    v_mfma_f32_16x16x32_bf16 v[216:219], v[144:147], v[136:139], v[216:219]
    v_mfma_f32_16x16x32_bf16 v[220:223], v[148:151], v[136:139], v[220:223]
    v_mfma_f32_16x16x32_bf16 v[224:227], v[152:155], v[136:139], v[224:227]
    v_mfma_f32_16x16x32_bf16 v[228:231], v[156:159], v[136:139], v[228:231]
    v_mfma_f32_16x16x32_bf16 v[232:235], v[160:163], v[136:139], v[232:235]
    v_mfma_f32_16x16x32_bf16 v[236:239], v[164:167], v[136:139], v[236:239]
    s_mov_b32 exec_lo, 0x00010001
    s_mov_b32 exec_hi, 0x00010001
    ds_write_b128 v18, v[212:215] offset:0
    ds_write_b128 v18, v[216:219] offset:64
    ds_write_b128 v18, v[220:223] offset:128
    ds_write_b128 v18, v[224:227] offset:192
    ds_write_b128 v18, v[228:231] offset:256
    ds_write_b128 v18, v[232:235] offset:320
    ds_write_b128 v18, v[236:239] offset:384
    s_mov_b64 exec, -1
    v_add_u32 v27, s21, v26
    v_xor_b32 v28, 64, v27
    s_waitcnt vmcnt(1)
    ds_read_b64_tr_b16 a[0:1], v27 offset:0
    ds_read_b64_tr_b16 a[2:3], v27 offset:512
    ds_read_b64_tr_b16 a[4:5], v28 offset:0
    ds_read_b64_tr_b16 a[6:7], v28 offset:512
    ds_read_b64_tr_b16 a[8:9], v27 offset:2048
    ds_read_b64_tr_b16 a[10:11], v27 offset:2560
    ds_read_b64_tr_b16 a[12:13], v28 offset:2048
    ds_read_b64_tr_b16 a[14:15], v28 offset:2560
    ds_read_b64_tr_b16 a[16:17], v27 offset:4096
    ds_read_b64_tr_b16 a[18:19], v27 offset:4608
    ds_read_b64_tr_b16 a[20:21], v28 offset:4096
    ds_read_b64_tr_b16 a[22:23], v28 offset:4608
    s_mov_b32 s19, 0
    s_waitcnt vmcnt(0)
    s_branch PCHK_12
POLL_10:
    s_mov_b64 exec, vcc
    buffer_load_dwordx4 v[32:35], v16, s[48:51], 0 offen sc1
    s_add_u32 s19, s19, 1
    s_waitcnt vmcnt(0)
PCHK_12:
    v_xor_b32 v32, s18, v32
    v_xor_b32 v33, s18, v33
    v_xor_b32 v34, s18, v34
    v_xor_b32 v35, s18, v35
    v_or3_b32 v32, v32, v33, v34
    v_or_b32 v32, v32, v35
    v_cmp_ne_u32 vcc, 0, v32
    s_cbranch_vccz PDONE_11
    s_cmp_lt_u32 s19, 65536
    s_cbranch_scc1 POLL_10
PDONE_11:
    s_mov_b64 exec, -1
    s_waitcnt lgkmcnt(0)
    s_barrier
    s_add_u32 m0, s21, 0
    s_movk_i32 s9, 0
    buffer_load_dwordx4 v12, s[64:67], s9 offen sc1 lds
    buffer_load_dwordx4 v12, s[64:67], s9 offen offset:1024 sc1 lds
    s_add_u32 m0, s21, 2048
    s_movk_i32 s9, 2048
    buffer_load_dwordx4 v12, s[64:67], s9 offen sc1 lds
    buffer_load_dwordx4 v12, s[64:67], s9 offen offset:1024 sc1 lds
    s_add_u32 m0, s21, 4096
    s_movk_i32 s9, 4096
    buffer_load_dwordx4 v12, s[64:67], s9 offen sc1 lds
    buffer_load_dwordx4 v12, s[64:67], s9 offen offset:1024 sc1 lds
    s_add_u32 m0, s21, 6144
    s_movk_i32 s9, 6144
    buffer_load_dwordx4 v12, s[64:67], s9 offen sc1 lds
    buffer_load_dwordx4 v12, s[64:67], s9 offen offset:1024 sc1 lds
    s_add_u32 m0, s21, 8192
    s_movk_i32 s9, 8192
    buffer_load_dwordx4 v12, s[64:67], s9 offen sc1 lds
    buffer_load_dwordx4 v12, s[64:67], s9 offen offset:1024 sc1 lds
    ds_read_b128 v[212:215], v17 offset:0
    ds_read_b128 v[216:219], v17 offset:64
    ds_read_b128 v[220:223], v17 offset:128
    ds_read_b128 v[224:227], v17 offset:192
    ds_read_b128 v[228:231], v17 offset:256
    ds_read_b128 v[232:235], v17 offset:320
    ds_read_b128 v[236:239], v17 offset:384
    ds_read_b128 v[140:143], v17 offset:448
    ds_read_b128 v[144:147], v17 offset:512
    ds_read_b128 v[148:151], v17 offset:576
    ds_read_b128 v[152:155], v17 offset:640
    ds_read_b128 v[156:159], v17 offset:704
    ds_read_b128 v[160:163], v17 offset:768
    ds_read_b128 v[164:167], v17 offset:832
    s_waitcnt lgkmcnt(7)
    ds_read_b128 v[168:171], v17 offset:896
    ds_read_b128 v[172:175], v17 offset:960
    ds_read_b128 v[176:179], v17 offset:1024
    ds_read_b128 v[180:183], v17 offset:1088
    ds_read_b128 v[184:187], v17 offset:1152
    ds_read_b128 v[188:191], v17 offset:1216
    ds_read_b128 v[192:195], v17 offset:1280
    s_waitcnt lgkmcnt(7)
    v_pk_add_f32 v[212:213], v[212:213], v[140:141]
    v_pk_add_f32 v[214:215], v[214:215], v[142:143]
    v_pk_add_f32 v[216:217], v[216:217], v[144:145]
    v_pk_add_f32 v[218:219], v[218:219], v[146:147]
    v_pk_add_f32 v[220:221], v[220:221], v[148:149]
    v_pk_add_f32 v[222:223], v[222:223], v[150:151]
    v_pk_add_f32 v[224:225], v[224:225], v[152:153]
    v_pk_add_f32 v[226:227], v[226:227], v[154:155]
    v_pk_add_f32 v[228:229], v[228:229], v[156:157]
    v_pk_add_f32 v[230:231], v[230:231], v[158:159]
    v_pk_add_f32 v[232:233], v[232:233], v[160:161]
    v_pk_add_f32 v[234:235], v[234:235], v[162:163]
    v_pk_add_f32 v[236:237], v[236:237], v[164:165]
    v_pk_add_f32 v[238:239], v[238:239], v[166:167]
    ds_read_b128 v[140:143], v17 offset:1344
    ds_read_b128 v[144:147], v17 offset:1408
    ds_read_b128 v[148:151], v17 offset:1472
    ds_read_b128 v[152:155], v17 offset:1536
    ds_read_b128 v[156:159], v17 offset:1600
    ds_read_b128 v[160:163], v17 offset:1664
    ds_read_b128 v[164:167], v17 offset:1728
    s_waitcnt lgkmcnt(7)
    v_pk_add_f32 v[212:213], v[212:213], v[168:169]
    v_pk_add_f32 v[214:215], v[214:215], v[170:171]
    v_pk_add_f32 v[216:217], v[216:217], v[172:173]
    v_pk_add_f32 v[218:219], v[218:219], v[174:175]
    v_pk_add_f32 v[220:221], v[220:221], v[176:177]
    v_pk_add_f32 v[222:223], v[222:223], v[178:179]
    v_pk_add_f32 v[224:225], v[224:225], v[180:181]
    v_pk_add_f32 v[226:227], v[226:227], v[182:183]
    v_pk_add_f32 v[228:229], v[228:229], v[184:185]
    v_pk_add_f32 v[230:231], v[230:231], v[186:187]
    v_pk_add_f32 v[232:233], v[232:233], v[188:189]
    v_pk_add_f32 v[234:235], v[234:235], v[190:191]
    v_pk_add_f32 v[236:237], v[236:237], v[192:193]
    v_pk_add_f32 v[238:239], v[238:239], v[194:195]
    s_waitcnt lgkmcnt(0)
    v_pk_add_f32 v[212:213], v[212:213], v[140:141]
    v_pk_add_f32 v[214:215], v[214:215], v[142:143]
    v_pk_add_f32 v[216:217], v[216:217], v[144:145]
    v_pk_add_f32 v[218:219], v[218:219], v[146:147]
    v_pk_add_f32 v[220:221], v[220:221], v[148:149]
    v_pk_add_f32 v[222:223], v[222:223], v[150:151]
    v_pk_add_f32 v[224:225], v[224:225], v[152:153]
    v_pk_add_f32 v[226:227], v[226:227], v[154:155]
    v_pk_add_f32 v[228:229], v[228:229], v[156:157]
    v_pk_add_f32 v[230:231], v[230:231], v[158:159]
    v_pk_add_f32 v[232:233], v[232:233], v[160:161]
    v_pk_add_f32 v[234:235], v[234:235], v[162:163]
    v_pk_add_f32 v[236:237], v[236:237], v[164:165]
    v_pk_add_f32 v[238:239], v[238:239], v[166:167]
    s_and_b32 s8, s23, 7
    s_barrier
    ds_read_b64_tr_b16 v[148:149], v8 offset:0
    ds_read_b64_tr_b16 v[150:151], v8 offset:3584
    ds_read_b64_tr_b16 v[152:153], v8 offset:32
    ds_read_b64_tr_b16 v[154:155], v8 offset:3616
    ds_read_b64_tr_b16 v[156:157], v8 offset:64
    ds_read_b64_tr_b16 v[158:159], v8 offset:3648
    ds_read_b64_tr_b16 v[160:161], v8 offset:96
    ds_read_b64_tr_b16 v[162:163], v8 offset:3680
    ds_read_b64_tr_b16 v[164:165], v8 offset:128
    ds_read_b64_tr_b16 v[166:167], v8 offset:3712
    ds_read_b64_tr_b16 v[168:169], v8 offset:160
    ds_read_b64_tr_b16 v[170:171], v8 offset:3744
    ds_read_b64_tr_b16 v[172:173], v8 offset:192
    ds_read_b64_tr_b16 v[174:175], v8 offset:3776
    s_waitcnt vmcnt(8)
    ds_read_b64_tr_b16 v[140:141], v10 offset:0
    ds_read_b64_tr_b16 v[142:143], v10 offset:1024
    ds_read_b64_tr_b16 v[144:145], v11 offset:0
    ds_read_b64_tr_b16 v[146:147], v11 offset:1024
    s_waitcnt lgkmcnt(0)
    v_mfma_f32_16x16x32_bf16 v[120:123], v[136:139], v[140:143], 0
    s_waitcnt vmcnt(6)
    ds_read_b64_tr_b16 v[176:177], v10 offset:2048
    v_mfma_f32_16x16x32_bf16 v[124:127], v[136:139], v[144:147], 0
    ds_read_b64_tr_b16 v[178:179], v10 offset:3072
    ds_read_b64_tr_b16 v[180:181], v11 offset:2048
    v_mfma_f32_16x16x32_bf16 v[64:67], v[148:151], v[140:143], 0
    ds_read_b64_tr_b16 v[182:183], v11 offset:3072
    ds_read_b64_tr_b16 v[184:185], v8 offset:7168
    v_mfma_f32_16x16x32_bf16 v[68:71], v[148:151], v[144:147], 0
    ds_read_b64_tr_b16 v[186:187], v8 offset:10752
    ds_read_b64_tr_b16 v[188:189], v8 offset:7200
    v_mfma_f32_16x16x32_bf16 v[72:75], v[152:155], v[140:143], 0
    ds_read_b64_tr_b16 v[190:191], v8 offset:10784
    ds_read_b64_tr_b16 v[192:193], v8 offset:7232
    v_mfma_f32_16x16x32_bf16 v[76:79], v[152:155], v[144:147], 0
    ds_read_b64_tr_b16 v[194:195], v8 offset:10816
    ds_read_b64_tr_b16 v[196:197], v8 offset:7264
    v_mfma_f32_16x16x32_bf16 v[80:83], v[156:159], v[140:143], 0
    ds_read_b64_tr_b16 v[198:199], v8 offset:10848
    ds_read_b64_tr_b16 v[200:201], v8 offset:7296
    v_mfma_f32_16x16x32_bf16 v[84:87], v[156:159], v[144:147], 0
    ds_read_b64_tr_b16 v[202:203], v8 offset:10880
    ds_read_b64_tr_b16 v[204:205], v8 offset:7328
    v_mfma_f32_16x16x32_bf16 v[88:91], v[160:163], v[140:143], 0
    ds_read_b64_tr_b16 v[206:207], v8 offset:10912
    ds_read_b64_tr_b16 v[208:209], v8 offset:7360
    v_mfma_f32_16x16x32_bf16 v[92:95], v[160:163], v[144:147], 0
    ds_read_b64_tr_b16 v[210:211], v8 offset:10944
    v_mfma_f32_16x16x32_bf16 v[96:99], v[164:167], v[140:143], 0
    s_add_u32 m0, s21, 10240
    s_movk_i32 s9, 10240
    v_mfma_f32_16x16x32_bf16 v[100:103], v[164:167], v[144:147], 0
    buffer_load_dwordx4 v12, s[64:67], s9 offen sc1 lds
    v_mfma_f32_16x16x32_bf16 v[104:107], v[168:171], v[140:143], 0
    buffer_load_dwordx4 v12, s[64:67], s9 offen offset:1024 sc1 lds
    v_mfma_f32_16x16x32_bf16 v[108:111], v[168:171], v[144:147], 0
    buffer_load_dword v247, v252, s[56:59], s41 offen
    s_add_u32 s41, s41, 36864
    v_mfma_f32_16x16x32_bf16 v[112:115], v[172:175], v[140:143], 0
    s_cmp_eq_u32 s8, 0
    v_mfma_f32_16x16x32_bf16 v[116:119], v[172:175], v[144:147], 0
    s_cbranch_scc0 L_S2R_0
    v_mfma_f32_16x16x32_bf16 v[128:131], v[140:143], v[140:143], 0
    v_mfma_f32_16x16x32_bf16 v[132:135], v[144:147], v[144:147], 0
L_S2R_0:
    s_waitcnt lgkmcnt(0)
    v_mfma_f32_16x16x32_bf16 v[120:123], v[136:139], v[176:179], v[120:123]
    s_waitcnt vmcnt(7)
    ds_read_b64_tr_b16 v[140:141], v10 offset:4096
    v_mfma_f32_16x16x32_bf16 v[124:127], v[136:139], v[180:183], v[124:127]
    ds_read_b64_tr_b16 v[142:143], v10 offset:5120
    ds_read_b64_tr_b16 v[144:145], v11 offset:4096
    v_mfma_f32_16x16x32_bf16 v[64:67], v[184:187], v[176:179], v[64:67]
    ds_read_b64_tr_b16 v[146:147], v11 offset:5120
    ds_read_b64_tr_b16 v[148:149], v8 offset:14336
    v_mfma_f32_16x16x32_bf16 v[68:71], v[184:187], v[180:183], v[68:71]
    ds_read_b64_tr_b16 v[150:151], v8 offset:17920
    ds_read_b64_tr_b16 v[152:153], v8 offset:14368
    v_mfma_f32_16x16x32_bf16 v[72:75], v[188:191], v[176:179], v[72:75]
    ds_read_b64_tr_b16 v[154:155], v8 offset:17952
    ds_read_b64_tr_b16 v[156:157], v8 offset:14400
    v_mfma_f32_16x16x32_bf16 v[76:79], v[188:191], v[180:183], v[76:79]
    ds_read_b64_tr_b16 v[158:159], v8 offset:17984
    ds_read_b64_tr_b16 v[160:161], v8 offset:14432
    v_mfma_f32_16x16x32_bf16 v[80:83], v[192:195], v[176:179], v[80:83]
    ds_read_b64_tr_b16 v[162:163], v8 offset:18016
    ds_read_b64_tr_b16 v[164:165], v8 offset:14464
    v_mfma_f32_16x16x32_bf16 v[84:87], v[192:195], v[180:183], v[84:87]
    ds_read_b64_tr_b16 v[166:167], v8 offset:18048
    ds_read_b64_tr_b16 v[168:169], v8 offset:14496
    v_mfma_f32_16x16x32_bf16 v[88:91], v[196:199], v[176:179], v[88:91]
    ds_read_b64_tr_b16 v[170:171], v8 offset:18080
    ds_read_b64_tr_b16 v[172:173], v8 offset:14528
    v_mfma_f32_16x16x32_bf16 v[92:95], v[196:199], v[180:183], v[92:95]
    ds_read_b64_tr_b16 v[174:175], v8 offset:18112
    v_mfma_f32_16x16x32_bf16 v[96:99], v[200:203], v[176:179], v[96:99]
    s_add_u32 m0, s21, 0
    s_movk_i32 s9, 12288
    v_mfma_f32_16x16x32_bf16 v[100:103], v[200:203], v[180:183], v[100:103]
    buffer_load_dwordx4 v12, s[64:67], s9 offen sc1 lds
    v_mfma_f32_16x16x32_bf16 v[104:107], v[204:207], v[176:179], v[104:107]
    buffer_load_dwordx4 v12, s[64:67], s9 offen offset:1024 sc1 lds
    v_mfma_f32_16x16x32_bf16 v[108:111], v[204:207], v[180:183], v[108:111]
    buffer_load_dword v247, v252, s[56:59], s41 offen
    s_add_u32 s41, s41, 36864
    v_mfma_f32_16x16x32_bf16 v[112:115], v[208:211], v[176:179], v[112:115]
    s_cmp_eq_u32 s8, 0
    v_mfma_f32_16x16x32_bf16 v[116:119], v[208:211], v[180:183], v[116:119]
    s_cbranch_scc0 L_S2R_1
    v_mfma_f32_16x16x32_bf16 v[128:131], v[176:179], v[176:179], v[128:131]
    v_mfma_f32_16x16x32_bf16 v[132:135], v[180:183], v[180:183], v[132:135]
L_S2R_1:
    s_waitcnt lgkmcnt(0)
    v_mfma_f32_16x16x32_bf16 v[120:123], v[136:139], v[140:143], v[120:123]
    s_waitcnt vmcnt(8)
    ds_read_b64_tr_b16 v[176:177], v10 offset:6144
    v_mfma_f32_16x16x32_bf16 v[124:127], v[136:139], v[144:147], v[124:127]
    ds_read_b64_tr_b16 v[178:179], v10 offset:7168
    ds_read_b64_tr_b16 v[180:181], v11 offset:6144
    v_mfma_f32_16x16x32_bf16 v[64:67], v[148:151], v[140:143], v[64:67]
    ds_read_b64_tr_b16 v[182:183], v11 offset:7168
    ds_read_b64_tr_b16 v[184:185], v8 offset:21504
    v_mfma_f32_16x16x32_bf16 v[68:71], v[148:151], v[144:147], v[68:71]
    ds_read_b64_tr_b16 v[186:187], v8 offset:25088
    ds_read_b64_tr_b16 v[188:189], v8 offset:21536
    v_mfma_f32_16x16x32_bf16 v[72:75], v[152:155], v[140:143], v[72:75]
    ds_read_b64_tr_b16 v[190:191], v8 offset:25120
    ds_read_b64_tr_b16 v[192:193], v8 offset:21568
    v_mfma_f32_16x16x32_bf16 v[76:79], v[152:155], v[144:147], v[76:79]
    ds_read_b64_tr_b16 v[194:195], v8 offset:25152
    ds_read_b64_tr_b16 v[196:197], v8 offset:21600
    v_mfma_f32_16x16x32_bf16 v[80:83], v[156:159], v[140:143], v[80:83]
    ds_read_b64_tr_b16 v[198:199], v8 offset:25184
    ds_read_b64_tr_b16 v[200:201], v8 offset:21632
    v_mfma_f32_16x16x32_bf16 v[84:87], v[156:159], v[144:147], v[84:87]
    ds_read_b64_tr_b16 v[202:203], v8 offset:25216
    ds_read_b64_tr_b16 v[204:205], v8 offset:21664
    v_mfma_f32_16x16x32_bf16 v[88:91], v[160:163], v[140:143], v[88:91]
    ds_read_b64_tr_b16 v[206:207], v8 offset:25248
    ds_read_b64_tr_b16 v[208:209], v8 offset:21696
    v_mfma_f32_16x16x32_bf16 v[92:95], v[160:163], v[144:147], v[92:95]
    ds_read_b64_tr_b16 v[210:211], v8 offset:25280
    v_mfma_f32_16x16x32_bf16 v[96:99], v[164:167], v[140:143], v[96:99]
    s_add_u32 m0, s21, 2048
    s_movk_i32 s9, 14336
    v_mfma_f32_16x16x32_bf16 v[100:103], v[164:167], v[144:147], v[100:103]
    buffer_load_dwordx4 v12, s[64:67], s9 offen sc1 lds
    v_mfma_f32_16x16x32_bf16 v[104:107], v[168:171], v[140:143], v[104:107]
    buffer_load_dwordx4 v12, s[64:67], s9 offen offset:1024 sc1 lds
    v_mfma_f32_16x16x32_bf16 v[108:111], v[168:171], v[144:147], v[108:111]
    buffer_load_dword v247, v252, s[56:59], s41 offen
    s_add_u32 s41, s41, 36864
    v_mfma_f32_16x16x32_bf16 v[112:115], v[172:175], v[140:143], v[112:115]
    s_cmp_eq_u32 s8, 1
    v_mfma_f32_16x16x32_bf16 v[116:119], v[172:175], v[144:147], v[116:119]
    s_cbranch_scc0 L_S2R_2
    v_mfma_f32_16x16x32_bf16 v[128:131], v[140:143], v[140:143], 0
    v_mfma_f32_16x16x32_bf16 v[132:135], v[144:147], v[144:147], 0
L_S2R_2:
    s_waitcnt lgkmcnt(0)
    v_mfma_f32_16x16x32_bf16 v[120:123], v[136:139], v[176:179], v[120:123]
    s_waitcnt vmcnt(9)
    ds_read_b64_tr_b16 v[140:141], v10 offset:8192
    v_mfma_f32_16x16x32_bf16 v[124:127], v[136:139], v[180:183], v[124:127]
    ds_read_b64_tr_b16 v[142:143], v10 offset:9216
    ds_read_b64_tr_b16 v[144:145], v11 offset:8192
    v_mfma_f32_16x16x32_bf16 v[64:67], v[184:187], v[176:179], v[64:67]
    ds_read_b64_tr_b16 v[146:147], v11 offset:9216
    ds_read_b64_tr_b16 v[148:149], v8 offset:28672
    v_mfma_f32_16x16x32_bf16 v[68:71], v[184:187], v[180:183], v[68:71]
    ds_read_b64_tr_b16 v[150:151], v8 offset:32256
    ds_read_b64_tr_b16 v[152:153], v8 offset:28704
    v_mfma_f32_16x16x32_bf16 v[72:75], v[188:191], v[176:179], v[72:75]
    ds_read_b64_tr_b16 v[154:155], v8 offset:32288
    ds_read_b64_tr_b16 v[156:157], v8 offset:28736
    v_mfma_f32_16x16x32_bf16 v[76:79], v[188:191], v[180:183], v[76:79]
    ds_read_b64_tr_b16 v[158:159], v8 offset:32320
    ds_read_b64_tr_b16 v[160:161], v8 offset:28768
    v_mfma_f32_16x16x32_bf16 v[80:83], v[192:195], v[176:179], v[80:83]
    ds_read_b64_tr_b16 v[162:163], v8 offset:32352
    ds_read_b64_tr_b16 v[164:165], v8 offset:28800
    v_mfma_f32_16x16x32_bf16 v[84:87], v[192:195], v[180:183], v[84:87]
    ds_read_b64_tr_b16 v[166:167], v8 offset:32384
    ds_read_b64_tr_b16 v[168:169], v8 offset:28832
    v_mfma_f32_16x16x32_bf16 v[88:91], v[196:199], v[176:179], v[88:91]
    ds_read_b64_tr_b16 v[170:171], v8 offset:32416
    ds_read_b64_tr_b16 v[172:173], v8 offset:28864
    v_mfma_f32_16x16x32_bf16 v[92:95], v[196:199], v[180:183], v[92:95]
    ds_read_b64_tr_b16 v[174:175], v8 offset:32448
    v_mfma_f32_16x16x32_bf16 v[96:99], v[200:203], v[176:179], v[96:99]
    s_add_u32 m0, s21, 4096
    s_movk_i32 s9, 16384
    v_mfma_f32_16x16x32_bf16 v[100:103], v[200:203], v[180:183], v[100:103]
    buffer_load_dwordx4 v12, s[64:67], s9 offen sc1 lds
    v_mfma_f32_16x16x32_bf16 v[104:107], v[204:207], v[176:179], v[104:107]
    buffer_load_dwordx4 v12, s[64:67], s9 offen offset:1024 sc1 lds
    v_mfma_f32_16x16x32_bf16 v[108:111], v[204:207], v[180:183], v[108:111]
    buffer_load_dword v247, v252, s[56:59], s41 offen
    s_add_u32 s41, s41, 36864
    v_mfma_f32_16x16x32_bf16 v[112:115], v[208:211], v[176:179], v[112:115]
    s_cmp_eq_u32 s8, 1
    v_mfma_f32_16x16x32_bf16 v[116:119], v[208:211], v[180:183], v[116:119]
    s_cbranch_scc0 L_S2R_3
    v_mfma_f32_16x16x32_bf16 v[128:131], v[176:179], v[176:179], v[128:131]
    v_mfma_f32_16x16x32_bf16 v[132:135], v[180:183], v[180:183], v[132:135]
L_S2R_3:
    s_waitcnt lgkmcnt(0)
    v_mfma_f32_16x16x32_bf16 v[120:123], v[136:139], v[140:143], v[120:123]
    s_waitcnt vmcnt(10)
    ds_read_b64_tr_b16 v[176:177], v10 offset:10240
    v_mfma_f32_16x16x32_bf16 v[124:127], v[136:139], v[144:147], v[124:127]
    ds_read_b64_tr_b16 v[178:179], v10 offset:11264
    ds_read_b64_tr_b16 v[180:181], v11 offset:10240
    v_mfma_f32_16x16x32_bf16 v[64:67], v[148:151], v[140:143], v[64:67]
    ds_read_b64_tr_b16 v[182:183], v11 offset:11264
    ds_read_b64_tr_b16 v[184:185], v8 offset:35840
    v_mfma_f32_16x16x32_bf16 v[68:71], v[148:151], v[144:147], v[68:71]
    ds_read_b64_tr_b16 v[186:187], v8 offset:39424
    ds_read_b64_tr_b16 v[188:189], v8 offset:35872
    v_mfma_f32_16x16x32_bf16 v[72:75], v[152:155], v[140:143], v[72:75]
    ds_read_b64_tr_b16 v[190:191], v8 offset:39456
    ds_read_b64_tr_b16 v[192:193], v8 offset:35904
    v_mfma_f32_16x16x32_bf16 v[76:79], v[152:155], v[144:147], v[76:79]
    ds_read_b64_tr_b16 v[194:195], v8 offset:39488
    ds_read_b64_tr_b16 v[196:197], v8 offset:35936
    v_mfma_f32_16x16x32_bf16 v[80:83], v[156:159], v[140:143], v[80:83]
    ds_read_b64_tr_b16 v[198:199], v8 offset:39520
    ds_read_b64_tr_b16 v[200:201], v8 offset:35968
    v_mfma_f32_16x16x32_bf16 v[84:87], v[156:159], v[144:147], v[84:87]
    ds_read_b64_tr_b16 v[202:203], v8 offset:39552
    ds_read_b64_tr_b16 v[204:205], v8 offset:36000
    v_mfma_f32_16x16x32_bf16 v[88:91], v[160:163], v[140:143], v[88:91]
    ds_read_b64_tr_b16 v[206:207], v8 offset:39584
    ds_read_b64_tr_b16 v[208:209], v8 offset:36032
    v_mfma_f32_16x16x32_bf16 v[92:95], v[160:163], v[144:147], v[92:95]
    ds_read_b64_tr_b16 v[210:211], v8 offset:39616
    v_mfma_f32_16x16x32_bf16 v[96:99], v[164:167], v[140:143], v[96:99]
    s_add_u32 m0, s21, 6144
    s_movk_i32 s9, 18432
    v_mfma_f32_16x16x32_bf16 v[100:103], v[164:167], v[144:147], v[100:103]
    buffer_load_dwordx4 v12, s[64:67], s9 offen sc1 lds
    v_mfma_f32_16x16x32_bf16 v[104:107], v[168:171], v[140:143], v[104:107]
    buffer_load_dwordx4 v12, s[64:67], s9 offen offset:1024 sc1 lds
    v_mfma_f32_16x16x32_bf16 v[108:111], v[168:171], v[144:147], v[108:111]
    buffer_load_dword v247, v252, s[56:59], s41 offen
    s_add_u32 s41, s41, 36864
    v_mfma_f32_16x16x32_bf16 v[112:115], v[172:175], v[140:143], v[112:115]
    s_cmp_eq_u32 s8, 2
    v_mfma_f32_16x16x32_bf16 v[116:119], v[172:175], v[144:147], v[116:119]
    s_cbranch_scc0 L_S2R_4
    v_mfma_f32_16x16x32_bf16 v[128:131], v[140:143], v[140:143], 0
    v_mfma_f32_16x16x32_bf16 v[132:135], v[144:147], v[144:147], 0
L_S2R_4:
    s_waitcnt lgkmcnt(0)
    v_mfma_f32_16x16x32_bf16 v[120:123], v[136:139], v[176:179], v[120:123]
    s_waitcnt vmcnt(10)
    ds_read_b64_tr_b16 v[140:141], v10 offset:0
    v_mfma_f32_16x16x32_bf16 v[124:127], v[136:139], v[180:183], v[124:127]
    ds_read_b64_tr_b16 v[142:143], v10 offset:1024
    ds_read_b64_tr_b16 v[144:145], v11 offset:0
    v_mfma_f32_16x16x32_bf16 v[64:67], v[184:187], v[176:179], v[64:67]
    ds_read_b64_tr_b16 v[146:147], v11 offset:1024
    ds_read_b64_tr_b16 v[148:149], v8 offset:43008
    v_mfma_f32_16x16x32_bf16 v[68:71], v[184:187], v[180:183], v[68:71]
    ds_read_b64_tr_b16 v[150:151], v8 offset:46592
    ds_read_b64_tr_b16 v[152:153], v8 offset:43040
    v_mfma_f32_16x16x32_bf16 v[72:75], v[188:191], v[176:179], v[72:75]
    ds_read_b64_tr_b16 v[154:155], v8 offset:46624
    ds_read_b64_tr_b16 v[156:157], v8 offset:43072
    v_mfma_f32_16x16x32_bf16 v[76:79], v[188:191], v[180:183], v[76:79]
    ds_read_b64_tr_b16 v[158:159], v8 offset:46656
    ds_read_b64_tr_b16 v[160:161], v8 offset:43104
    v_mfma_f32_16x16x32_bf16 v[80:83], v[192:195], v[176:179], v[80:83]
    ds_read_b64_tr_b16 v[162:163], v8 offset:46688
    ds_read_b64_tr_b16 v[164:165], v8 offset:43136
    v_mfma_f32_16x16x32_bf16 v[84:87], v[192:195], v[180:183], v[84:87]
    ds_read_b64_tr_b16 v[166:167], v8 offset:46720
    ds_read_b64_tr_b16 v[168:169], v8 offset:43168
    v_mfma_f32_16x16x32_bf16 v[88:91], v[196:199], v[176:179], v[88:91]
    ds_read_b64_tr_b16 v[170:171], v8 offset:46752
    ds_read_b64_tr_b16 v[172:173], v8 offset:43200
    v_mfma_f32_16x16x32_bf16 v[92:95], v[196:199], v[180:183], v[92:95]
    ds_read_b64_tr_b16 v[174:175], v8 offset:46784
    v_mfma_f32_16x16x32_bf16 v[96:99], v[200:203], v[176:179], v[96:99]
    s_add_u32 m0, s21, 8192
    s_movk_i32 s9, 20480
    v_mfma_f32_16x16x32_bf16 v[100:103], v[200:203], v[180:183], v[100:103]
    buffer_load_dwordx4 v12, s[64:67], s9 offen sc1 lds
    v_mfma_f32_16x16x32_bf16 v[104:107], v[204:207], v[176:179], v[104:107]
    buffer_load_dwordx4 v12, s[64:67], s9 offen offset:1024 sc1 lds
    v_mfma_f32_16x16x32_bf16 v[108:111], v[204:207], v[180:183], v[108:111]
    buffer_load_dword v247, v252, s[56:59], s41 offen
    s_add_u32 s41, s41, 36864
    v_mfma_f32_16x16x32_bf16 v[112:115], v[208:211], v[176:179], v[112:115]
    s_cmp_eq_u32 s8, 2
    v_mfma_f32_16x16x32_bf16 v[116:119], v[208:211], v[180:183], v[116:119]
    s_cbranch_scc0 L_S2R_5
    v_mfma_f32_16x16x32_bf16 v[128:131], v[176:179], v[176:179], v[128:131]
    v_mfma_f32_16x16x32_bf16 v[132:135], v[180:183], v[180:183], v[132:135]
L_S2R_5:
    s_waitcnt lgkmcnt(0)
    v_mfma_f32_16x16x32_bf16 v[120:123], v[136:139], v[140:143], v[120:123]
    s_waitcnt vmcnt(10)
    ds_read_b64_tr_b16 v[176:177], v10 offset:2048
    v_mfma_f32_16x16x32_bf16 v[124:127], v[136:139], v[144:147], v[124:127]
    ds_read_b64_tr_b16 v[178:179], v10 offset:3072
    ds_read_b64_tr_b16 v[180:181], v11 offset:2048
    v_mfma_f32_16x16x32_bf16 v[64:67], v[148:151], v[140:143], v[64:67]
    ds_read_b64_tr_b16 v[182:183], v11 offset:3072
    ds_read_b64_tr_b16 v[184:185], v8 offset:50176
    v_mfma_f32_16x16x32_bf16 v[68:71], v[148:151], v[144:147], v[68:71]
    ds_read_b64_tr_b16 v[186:187], v8 offset:53760
    ds_read_b64_tr_b16 v[188:189], v8 offset:50208
    v_mfma_f32_16x16x32_bf16 v[72:75], v[152:155], v[140:143], v[72:75]
    ds_read_b64_tr_b16 v[190:191], v8 offset:53792
    ds_read_b64_tr_b16 v[192:193], v8 offset:50240
    v_mfma_f32_16x16x32_bf16 v[76:79], v[152:155], v[144:147], v[76:79]
    ds_read_b64_tr_b16 v[194:195], v8 offset:53824
    ds_read_b64_tr_b16 v[196:197], v8 offset:50272
    v_mfma_f32_16x16x32_bf16 v[80:83], v[156:159], v[140:143], v[80:83]
    ds_read_b64_tr_b16 v[198:199], v8 offset:53856
    ds_read_b64_tr_b16 v[200:201], v8 offset:50304
    v_mfma_f32_16x16x32_bf16 v[84:87], v[156:159], v[144:147], v[84:87]
    ds_read_b64_tr_b16 v[202:203], v8 offset:53888
    ds_read_b64_tr_b16 v[204:205], v8 offset:50336
    v_mfma_f32_16x16x32_bf16 v[88:91], v[160:163], v[140:143], v[88:91]
    ds_read_b64_tr_b16 v[206:207], v8 offset:53920
    ds_read_b64_tr_b16 v[208:209], v8 offset:50368
    v_mfma_f32_16x16x32_bf16 v[92:95], v[160:163], v[144:147], v[92:95]
    ds_read_b64_tr_b16 v[210:211], v8 offset:53952
    v_mfma_f32_16x16x32_bf16 v[96:99], v[164:167], v[140:143], v[96:99]
    s_add_u32 m0, s21, 10240
    s_movk_i32 s9, 22528
    v_mfma_f32_16x16x32_bf16 v[100:103], v[164:167], v[144:147], v[100:103]
    buffer_load_dwordx4 v12, s[64:67], s9 offen sc1 lds
    v_mfma_f32_16x16x32_bf16 v[104:107], v[168:171], v[140:143], v[104:107]
    buffer_load_dwordx4 v12, s[64:67], s9 offen offset:1024 sc1 lds
    v_mfma_f32_16x16x32_bf16 v[108:111], v[168:171], v[144:147], v[108:111]
    buffer_load_dword v247, v252, s[56:59], s41 offen
    s_add_u32 s41, s41, 36864
    v_mfma_f32_16x16x32_bf16 v[112:115], v[172:175], v[140:143], v[112:115]
    s_cmp_eq_u32 s8, 3
    v_mfma_f32_16x16x32_bf16 v[116:119], v[172:175], v[144:147], v[116:119]
    s_cbranch_scc0 L_S2R_6
    v_mfma_f32_16x16x32_bf16 v[128:131], v[140:143], v[140:143], 0
    v_mfma_f32_16x16x32_bf16 v[132:135], v[144:147], v[144:147], 0
L_S2R_6:
    s_waitcnt lgkmcnt(0)
    v_mfma_f32_16x16x32_bf16 v[120:123], v[136:139], v[176:179], v[120:123]
    s_waitcnt vmcnt(10)
    ds_read_b64_tr_b16 v[140:141], v10 offset:4096
    s_barrier
    v_mfma_f32_16x16x32_bf16 v[124:127], v[136:139], v[180:183], v[124:127]
    ds_read_b64_tr_b16 v[142:143], v10 offset:5120
    ds_read_b64_tr_b16 v[144:145], v11 offset:4096
    v_mfma_f32_16x16x32_bf16 v[64:67], v[184:187], v[176:179], v[64:67]
    ds_read_b64_tr_b16 v[146:147], v11 offset:5120
    ds_read_b64_tr_b16 v[148:149], v9 offset:0
    v_mfma_f32_16x16x32_bf16 v[68:71], v[184:187], v[180:183], v[68:71]
    ds_read_b64_tr_b16 v[150:151], v9 offset:3584
    ds_read_b64_tr_b16 v[152:153], v9 offset:32
    v_mfma_f32_16x16x32_bf16 v[72:75], v[188:191], v[176:179], v[72:75]
    ds_read_b64_tr_b16 v[154:155], v9 offset:3616
    ds_read_b64_tr_b16 v[156:157], v9 offset:64
    v_mfma_f32_16x16x32_bf16 v[76:79], v[188:191], v[180:183], v[76:79]
    ds_read_b64_tr_b16 v[158:159], v9 offset:3648
    ds_read_b64_tr_b16 v[160:161], v9 offset:96
    v_mfma_f32_16x16x32_bf16 v[80:83], v[192:195], v[176:179], v[80:83]
    ds_read_b64_tr_b16 v[162:163], v9 offset:3680
    ds_read_b64_tr_b16 v[164:165], v9 offset:128
    v_mfma_f32_16x16x32_bf16 v[84:87], v[192:195], v[180:183], v[84:87]
    ds_read_b64_tr_b16 v[166:167], v9 offset:3712
    ds_read_b64_tr_b16 v[168:169], v9 offset:160
    v_mfma_f32_16x16x32_bf16 v[88:91], v[196:199], v[176:179], v[88:91]
    ds_read_b64_tr_b16 v[170:171], v9 offset:3744
    ds_read_b64_tr_b16 v[172:173], v9 offset:192
    v_mfma_f32_16x16x32_bf16 v[92:95], v[196:199], v[180:183], v[92:95]
    ds_read_b64_tr_b16 v[174:175], v9 offset:3776
    v_mfma_f32_16x16x32_bf16 v[96:99], v[200:203], v[176:179], v[96:99]
    s_add_u32 m0, s21, 0
    s_movk_i32 s9, 24576
    v_mfma_f32_16x16x32_bf16 v[100:103], v[200:203], v[180:183], v[100:103]
    buffer_load_dwordx4 v12, s[64:67], s9 offen sc1 lds
    v_mfma_f32_16x16x32_bf16 v[104:107], v[204:207], v[176:179], v[104:107]
    buffer_load_dwordx4 v12, s[64:67], s9 offen offset:1024 sc1 lds
    v_mfma_f32_16x16x32_bf16 v[108:111], v[204:207], v[180:183], v[108:111]
    buffer_load_dword v247, v252, s[56:59], s41 offen
    s_add_u32 s41, s41, 36864
    v_mfma_f32_16x16x32_bf16 v[112:115], v[208:211], v[176:179], v[112:115]
    s_cmp_eq_u32 s8, 3
    v_mfma_f32_16x16x32_bf16 v[116:119], v[208:211], v[180:183], v[116:119]
    s_cbranch_scc0 L_S2R_7
    v_mfma_f32_16x16x32_bf16 v[128:131], v[176:179], v[176:179], v[128:131]
    v_mfma_f32_16x16x32_bf16 v[132:135], v[180:183], v[180:183], v[132:135]
L_S2R_7:
    s_waitcnt lgkmcnt(0)
    v_mfma_f32_16x16x32_bf16 v[120:123], v[136:139], v[140:143], v[120:123]
    s_waitcnt vmcnt(10)
    ds_read_b64_tr_b16 v[176:177], v10 offset:6144
    v_mfma_f32_16x16x32_bf16 v[124:127], v[136:139], v[144:147], v[124:127]
    ds_read_b64_tr_b16 v[178:179], v10 offset:7168
    ds_read_b64_tr_b16 v[180:181], v11 offset:6144
    v_mfma_f32_16x16x32_bf16 v[64:67], v[148:151], v[140:143], v[64:67]
    ds_read_b64_tr_b16 v[182:183], v11 offset:7168
    ds_read_b64_tr_b16 v[184:185], v9 offset:7168
    v_mfma_f32_16x16x32_bf16 v[68:71], v[148:151], v[144:147], v[68:71]
    ds_read_b64_tr_b16 v[186:187], v9 offset:10752
    ds_read_b64_tr_b16 v[188:189], v9 offset:7200
    v_mfma_f32_16x16x32_bf16 v[72:75], v[152:155], v[140:143], v[72:75]
    ds_read_b64_tr_b16 v[190:191], v9 offset:10784
    ds_read_b64_tr_b16 v[192:193], v9 offset:7232
    v_mfma_f32_16x16x32_bf16 v[76:79], v[152:155], v[144:147], v[76:79]
    ds_read_b64_tr_b16 v[194:195], v9 offset:10816
    ds_read_b64_tr_b16 v[196:197], v9 offset:7264
    v_mfma_f32_16x16x32_bf16 v[80:83], v[156:159], v[140:143], v[80:83]
    ds_read_b64_tr_b16 v[198:199], v9 offset:10848
    ds_read_b64_tr_b16 v[200:201], v9 offset:7296
    v_mfma_f32_16x16x32_bf16 v[84:87], v[156:159], v[144:147], v[84:87]
    ds_read_b64_tr_b16 v[202:203], v9 offset:10880
    ds_read_b64_tr_b16 v[204:205], v9 offset:7328
    v_mfma_f32_16x16x32_bf16 v[88:91], v[160:163], v[140:143], v[88:91]
    ds_read_b64_tr_b16 v[206:207], v9 offset:10912
    ds_read_b64_tr_b16 v[208:209], v9 offset:7360
    v_mfma_f32_16x16x32_bf16 v[92:95], v[160:163], v[144:147], v[92:95]
    ds_read_b64_tr_b16 v[210:211], v9 offset:10944
    v_mfma_f32_16x16x32_bf16 v[96:99], v[164:167], v[140:143], v[96:99]
    s_add_u32 m0, s21, 2048
    s_movk_i32 s9, 26624
    v_mfma_f32_16x16x32_bf16 v[100:103], v[164:167], v[144:147], v[100:103]
    buffer_load_dwordx4 v12, s[64:67], s9 offen sc1 lds
    v_mfma_f32_16x16x32_bf16 v[104:107], v[168:171], v[140:143], v[104:107]
    buffer_load_dwordx4 v12, s[64:67], s9 offen offset:1024 sc1 lds
    v_mfma_f32_16x16x32_bf16 v[108:111], v[168:171], v[144:147], v[108:111]
    s_add_u32 m0, s14, 0
    s_add_u32 s13, s13, 8192
    buffer_load_dwordx4 v25, s[56:59], s13 offen lds
    v_mfma_f32_16x16x32_bf16 v[112:115], v[172:175], v[140:143], v[112:115]
    s_cmp_eq_u32 s8, 4
    v_mfma_f32_16x16x32_bf16 v[116:119], v[172:175], v[144:147], v[116:119]
    s_cbranch_scc0 L_S2R_8
    v_mfma_f32_16x16x32_bf16 v[128:131], v[140:143], v[140:143], 0
    v_mfma_f32_16x16x32_bf16 v[132:135], v[144:147], v[144:147], 0
L_S2R_8:
    s_waitcnt lgkmcnt(0)
    v_mfma_f32_16x16x32_bf16 v[120:123], v[136:139], v[176:179], v[120:123]
    s_waitcnt vmcnt(10)
    ds_read_b64_tr_b16 v[140:141], v10 offset:8192
    v_mfma_f32_16x16x32_bf16 v[124:127], v[136:139], v[180:183], v[124:127]
    ds_read_b64_tr_b16 v[142:143], v10 offset:9216
    ds_read_b64_tr_b16 v[144:145], v11 offset:8192
    v_mfma_f32_16x16x32_bf16 v[64:67], v[184:187], v[176:179], v[64:67]
    ds_read_b64_tr_b16 v[146:147], v11 offset:9216
    ds_read_b64_tr_b16 v[148:149], v9 offset:14336
    v_mfma_f32_16x16x32_bf16 v[68:71], v[184:187], v[180:183], v[68:71]
    ds_read_b64_tr_b16 v[150:151], v9 offset:17920
    ds_read_b64_tr_b16 v[152:153], v9 offset:14368
    v_mfma_f32_16x16x32_bf16 v[72:75], v[188:191], v[176:179], v[72:75]
    ds_read_b64_tr_b16 v[154:155], v9 offset:17952
    ds_read_b64_tr_b16 v[156:157], v9 offset:14400
    v_mfma_f32_16x16x32_bf16 v[76:79], v[188:191], v[180:183], v[76:79]
    ds_read_b64_tr_b16 v[158:159], v9 offset:17984
    ds_read_b64_tr_b16 v[160:161], v9 offset:14432
    v_mfma_f32_16x16x32_bf16 v[80:83], v[192:195], v[176:179], v[80:83]
    ds_read_b64_tr_b16 v[162:163], v9 offset:18016
    ds_read_b64_tr_b16 v[164:165], v9 offset:14464
    v_mfma_f32_16x16x32_bf16 v[84:87], v[192:195], v[180:183], v[84:87]
    ds_read_b64_tr_b16 v[166:167], v9 offset:18048
    ds_read_b64_tr_b16 v[168:169], v9 offset:14496
    v_mfma_f32_16x16x32_bf16 v[88:91], v[196:199], v[176:179], v[88:91]
    ds_read_b64_tr_b16 v[170:171], v9 offset:18080
    ds_read_b64_tr_b16 v[172:173], v9 offset:14528
    v_mfma_f32_16x16x32_bf16 v[92:95], v[196:199], v[180:183], v[92:95]
    ds_read_b64_tr_b16 v[174:175], v9 offset:18112
    v_mfma_f32_16x16x32_bf16 v[96:99], v[200:203], v[176:179], v[96:99]
    s_add_u32 m0, s21, 4096
    s_movk_i32 s9, 28672
    v_mfma_f32_16x16x32_bf16 v[100:103], v[200:203], v[180:183], v[100:103]
    buffer_load_dwordx4 v12, s[64:67], s9 offen sc1 lds
    v_mfma_f32_16x16x32_bf16 v[104:107], v[204:207], v[176:179], v[104:107]
    buffer_load_dwordx4 v12, s[64:67], s9 offen offset:1024 sc1 lds
    v_mfma_f32_16x16x32_bf16 v[108:111], v[204:207], v[180:183], v[108:111]
    s_add_u32 m0, s14, 1024
    s_add_u32 s13, s13, 8192
    buffer_load_dwordx4 v25, s[56:59], s13 offen lds
    v_mfma_f32_16x16x32_bf16 v[112:115], v[208:211], v[176:179], v[112:115]
    s_cmp_eq_u32 s8, 4
    v_mfma_f32_16x16x32_bf16 v[116:119], v[208:211], v[180:183], v[116:119]
    s_cbranch_scc0 L_S2R_9
    v_mfma_f32_16x16x32_bf16 v[128:131], v[176:179], v[176:179], v[128:131]
    v_mfma_f32_16x16x32_bf16 v[132:135], v[180:183], v[180:183], v[132:135]
L_S2R_9:
    s_waitcnt lgkmcnt(0)
    v_mfma_f32_16x16x32_bf16 v[120:123], v[136:139], v[140:143], v[120:123]
    s_waitcnt vmcnt(10)
    ds_read_b64_tr_b16 v[176:177], v10 offset:10240
    v_mfma_f32_16x16x32_bf16 v[124:127], v[136:139], v[144:147], v[124:127]
    ds_read_b64_tr_b16 v[178:179], v10 offset:11264
    ds_read_b64_tr_b16 v[180:181], v11 offset:10240
    v_mfma_f32_16x16x32_bf16 v[64:67], v[148:151], v[140:143], v[64:67]
    ds_read_b64_tr_b16 v[182:183], v11 offset:11264
    ds_read_b64_tr_b16 v[184:185], v9 offset:21504
    v_mfma_f32_16x16x32_bf16 v[68:71], v[148:151], v[144:147], v[68:71]
    ds_read_b64_tr_b16 v[186:187], v9 offset:25088
    ds_read_b64_tr_b16 v[188:189], v9 offset:21536
    v_mfma_f32_16x16x32_bf16 v[72:75], v[152:155], v[140:143], v[72:75]
    ds_read_b64_tr_b16 v[190:191], v9 offset:25120
    ds_read_b64_tr_b16 v[192:193], v9 offset:21568
    v_mfma_f32_16x16x32_bf16 v[76:79], v[152:155], v[144:147], v[76:79]
    ds_read_b64_tr_b16 v[194:195], v9 offset:25152
    ds_read_b64_tr_b16 v[196:197], v9 offset:21600
    v_mfma_f32_16x16x32_bf16 v[80:83], v[156:159], v[140:143], v[80:83]
    ds_read_b64_tr_b16 v[198:199], v9 offset:25184
    ds_read_b64_tr_b16 v[200:201], v9 offset:21632
    v_mfma_f32_16x16x32_bf16 v[84:87], v[156:159], v[144:147], v[84:87]
    ds_read_b64_tr_b16 v[202:203], v9 offset:25216
    ds_read_b64_tr_b16 v[204:205], v9 offset:21664
    v_mfma_f32_16x16x32_bf16 v[88:91], v[160:163], v[140:143], v[88:91]
    ds_read_b64_tr_b16 v[206:207], v9 offset:25248
    ds_read_b64_tr_b16 v[208:209], v9 offset:21696
    v_mfma_f32_16x16x32_bf16 v[92:95], v[160:163], v[144:147], v[92:95]
    ds_read_b64_tr_b16 v[210:211], v9 offset:25280
    v_mfma_f32_16x16x32_bf16 v[96:99], v[164:167], v[140:143], v[96:99]
    s_add_u32 m0, s21, 6144
    s_movk_i32 s9, 30720
    v_mfma_f32_16x16x32_bf16 v[100:103], v[164:167], v[144:147], v[100:103]
    buffer_load_dwordx4 v12, s[64:67], s9 offen sc1 lds
    v_mfma_f32_16x16x32_bf16 v[104:107], v[168:171], v[140:143], v[104:107]
    buffer_load_dwordx4 v12, s[64:67], s9 offen offset:1024 sc1 lds
    v_mfma_f32_16x16x32_bf16 v[108:111], v[168:171], v[144:147], v[108:111]
    s_add_u32 m0, s14, 2048
    s_add_u32 s13, s13, 8192
    buffer_load_dwordx4 v25, s[56:59], s13 offen lds
    v_mfma_f32_16x16x32_bf16 v[112:115], v[172:175], v[140:143], v[112:115]
    s_cmp_eq_u32 s8, 5
    v_mfma_f32_16x16x32_bf16 v[116:119], v[172:175], v[144:147], v[116:119]
    s_cbranch_scc0 L_S2R_10
    v_mfma_f32_16x16x32_bf16 v[128:131], v[140:143], v[140:143], 0
    v_mfma_f32_16x16x32_bf16 v[132:135], v[144:147], v[144:147], 0
L_S2R_10:
    s_waitcnt lgkmcnt(0)
    v_mfma_f32_16x16x32_bf16 v[120:123], v[136:139], v[176:179], v[120:123]
    s_waitcnt vmcnt(10)
    ds_read_b64_tr_b16 v[140:141], v10 offset:0
    v_mfma_f32_16x16x32_bf16 v[124:127], v[136:139], v[180:183], v[124:127]
    ds_read_b64_tr_b16 v[142:143], v10 offset:1024
    ds_read_b64_tr_b16 v[144:145], v11 offset:0
    v_mfma_f32_16x16x32_bf16 v[64:67], v[184:187], v[176:179], v[64:67]
    ds_read_b64_tr_b16 v[146:147], v11 offset:1024
    ds_read_b64_tr_b16 v[148:149], v9 offset:28672
    v_mfma_f32_16x16x32_bf16 v[68:71], v[184:187], v[180:183], v[68:71]
    ds_read_b64_tr_b16 v[150:151], v9 offset:32256
    ds_read_b64_tr_b16 v[152:153], v9 offset:28704
    v_mfma_f32_16x16x32_bf16 v[72:75], v[188:191], v[176:179], v[72:75]
    ds_read_b64_tr_b16 v[154:155], v9 offset:32288
    ds_read_b64_tr_b16 v[156:157], v9 offset:28736
    v_mfma_f32_16x16x32_bf16 v[76:79], v[188:191], v[180:183], v[76:79]
    ds_read_b64_tr_b16 v[158:159], v9 offset:32320
    ds_read_b64_tr_b16 v[160:161], v9 offset:28768
    v_mfma_f32_16x16x32_bf16 v[80:83], v[192:195], v[176:179], v[80:83]
    ds_read_b64_tr_b16 v[162:163], v9 offset:32352
    ds_read_b64_tr_b16 v[164:165], v9 offset:28800
    v_mfma_f32_16x16x32_bf16 v[84:87], v[192:195], v[180:183], v[84:87]
    ds_read_b64_tr_b16 v[166:167], v9 offset:32384
    ds_read_b64_tr_b16 v[168:169], v9 offset:28832
    v_mfma_f32_16x16x32_bf16 v[88:91], v[196:199], v[176:179], v[88:91]
    ds_read_b64_tr_b16 v[170:171], v9 offset:32416
    ds_read_b64_tr_b16 v[172:173], v9 offset:28864
    v_mfma_f32_16x16x32_bf16 v[92:95], v[196:199], v[180:183], v[92:95]
    ds_read_b64_tr_b16 v[174:175], v9 offset:32448
    v_mfma_f32_16x16x32_bf16 v[96:99], v[200:203], v[176:179], v[96:99]
    s_add_u32 m0, s14, 3072
    s_add_u32 s13, s13, 8192
    buffer_load_dwordx4 v25, s[56:59], s13 offen lds
    v_mfma_f32_16x16x32_bf16 v[100:103], v[200:203], v[180:183], v[100:103]
    v_mfma_f32_16x16x32_bf16 v[104:107], v[204:207], v[176:179], v[104:107]
    v_mfma_f32_16x16x32_bf16 v[108:111], v[204:207], v[180:183], v[108:111]
    v_mfma_f32_16x16x32_bf16 v[112:115], v[208:211], v[176:179], v[112:115]
    s_cmp_eq_u32 s8, 5
    v_mfma_f32_16x16x32_bf16 v[116:119], v[208:211], v[180:183], v[116:119]
    s_cbranch_scc0 L_S2R_11
    v_mfma_f32_16x16x32_bf16 v[128:131], v[176:179], v[176:179], v[128:131]
    v_mfma_f32_16x16x32_bf16 v[132:135], v[180:183], v[180:183], v[132:135]
L_S2R_11:
    s_waitcnt lgkmcnt(0)
    v_mfma_f32_16x16x32_bf16 v[120:123], v[136:139], v[140:143], v[120:123]
    s_waitcnt vmcnt(8)
    ds_read_b64_tr_b16 v[176:177], v10 offset:2048
    v_mfma_f32_16x16x32_bf16 v[124:127], v[136:139], v[144:147], v[124:127]
    ds_read_b64_tr_b16 v[178:179], v10 offset:3072
    ds_read_b64_tr_b16 v[180:181], v11 offset:2048
    v_mfma_f32_16x16x32_bf16 v[64:67], v[148:151], v[140:143], v[64:67]
    ds_read_b64_tr_b16 v[182:183], v11 offset:3072
    ds_read_b64_tr_b16 v[184:185], v9 offset:35840
    v_mfma_f32_16x16x32_bf16 v[68:71], v[148:151], v[144:147], v[68:71]
    ds_read_b64_tr_b16 v[186:187], v9 offset:39424
    ds_read_b64_tr_b16 v[188:189], v9 offset:35872
    v_mfma_f32_16x16x32_bf16 v[72:75], v[152:155], v[140:143], v[72:75]
    ds_read_b64_tr_b16 v[190:191], v9 offset:39456
    ds_read_b64_tr_b16 v[192:193], v9 offset:35904
    v_mfma_f32_16x16x32_bf16 v[76:79], v[152:155], v[144:147], v[76:79]
    ds_read_b64_tr_b16 v[194:195], v9 offset:39488
    ds_read_b64_tr_b16 v[196:197], v9 offset:35936
    v_mfma_f32_16x16x32_bf16 v[80:83], v[156:159], v[140:143], v[80:83]
    ds_read_b64_tr_b16 v[198:199], v9 offset:39520
    ds_read_b64_tr_b16 v[200:201], v9 offset:35968
    v_mfma_f32_16x16x32_bf16 v[84:87], v[156:159], v[144:147], v[84:87]
    ds_read_b64_tr_b16 v[202:203], v9 offset:39552
    ds_read_b64_tr_b16 v[204:205], v9 offset:36000
    v_mfma_f32_16x16x32_bf16 v[88:91], v[160:163], v[140:143], v[88:91]
    ds_read_b64_tr_b16 v[206:207], v9 offset:39584
    ds_read_b64_tr_b16 v[208:209], v9 offset:36032
    v_mfma_f32_16x16x32_bf16 v[92:95], v[160:163], v[144:147], v[92:95]
    ds_read_b64_tr_b16 v[210:211], v9 offset:39616
    v_mfma_f32_16x16x32_bf16 v[96:99], v[164:167], v[140:143], v[96:99]
    s_add_u32 m0, s14, 4096
    s_add_u32 s13, s13, 8192
    buffer_load_dwordx4 v25, s[56:59], s13 offen lds
    v_mfma_f32_16x16x32_bf16 v[100:103], v[164:167], v[144:147], v[100:103]
    s_add_u32 m0, s14, 5120
    s_add_u32 s13, s13, 8192
    buffer_load_dwordx4 v25, s[56:59], s13 offen lds
    v_mfma_f32_16x16x32_bf16 v[104:107], v[168:171], v[140:143], v[104:107]
    s_add_u32 m0, s14, 6144
    s_add_u32 s13, s13, 8192
    buffer_load_dwordx4 v25, s[56:59], s13 offen lds
    v_mfma_f32_16x16x32_bf16 v[108:111], v[168:171], v[144:147], v[108:111]
    v_mfma_f32_16x16x32_bf16 v[112:115], v[172:175], v[140:143], v[112:115]
    s_cmp_eq_u32 s8, 6
    v_mfma_f32_16x16x32_bf16 v[116:119], v[172:175], v[144:147], v[116:119]
    s_cbranch_scc0 L_S2R_12
    v_mfma_f32_16x16x32_bf16 v[128:131], v[140:143], v[140:143], 0
    v_mfma_f32_16x16x32_bf16 v[132:135], v[144:147], v[144:147], 0
L_S2R_12:
    s_waitcnt lgkmcnt(0)
    v_mfma_f32_16x16x32_bf16 v[120:123], v[136:139], v[176:179], v[120:123]
    s_waitcnt vmcnt(8)
    ds_read_b64_tr_b16 v[140:141], v10 offset:4096
    v_mfma_f32_16x16x32_bf16 v[124:127], v[136:139], v[180:183], v[124:127]
    ds_read_b64_tr_b16 v[142:143], v10 offset:5120
    ds_read_b64_tr_b16 v[144:145], v11 offset:4096
    v_mfma_f32_16x16x32_bf16 v[64:67], v[184:187], v[176:179], v[64:67]
    ds_read_b64_tr_b16 v[146:147], v11 offset:5120
    ds_read_b64_tr_b16 v[148:149], v9 offset:43008
    v_mfma_f32_16x16x32_bf16 v[68:71], v[184:187], v[180:183], v[68:71]
    ds_read_b64_tr_b16 v[150:151], v9 offset:46592
    ds_read_b64_tr_b16 v[152:153], v9 offset:43040
    v_mfma_f32_16x16x32_bf16 v[72:75], v[188:191], v[176:179], v[72:75]
    ds_read_b64_tr_b16 v[154:155], v9 offset:46624
    ds_read_b64_tr_b16 v[156:157], v9 offset:43072
    v_mfma_f32_16x16x32_bf16 v[76:79], v[188:191], v[180:183], v[76:79]
    ds_read_b64_tr_b16 v[158:159], v9 offset:46656
    ds_read_b64_tr_b16 v[160:161], v9 offset:43104
    v_mfma_f32_16x16x32_bf16 v[80:83], v[192:195], v[176:179], v[80:83]
    ds_read_b64_tr_b16 v[162:163], v9 offset:46688
    ds_read_b64_tr_b16 v[164:165], v9 offset:43136
    v_mfma_f32_16x16x32_bf16 v[84:87], v[192:195], v[180:183], v[84:87]
    ds_read_b64_tr_b16 v[166:167], v9 offset:46720
    ds_read_b64_tr_b16 v[168:169], v9 offset:43168
    v_mfma_f32_16x16x32_bf16 v[88:91], v[196:199], v[176:179], v[88:91]
    ds_read_b64_tr_b16 v[170:171], v9 offset:46752
    ds_read_b64_tr_b16 v[172:173], v9 offset:43200
    v_mfma_f32_16x16x32_bf16 v[92:95], v[196:199], v[180:183], v[92:95]
    ds_read_b64_tr_b16 v[174:175], v9 offset:46784
    v_mfma_f32_16x16x32_bf16 v[96:99], v[200:203], v[176:179], v[96:99]
    s_add_u32 m0, s14, 7168
    s_add_u32 s13, s13, 8192
    buffer_load_dwordx4 v25, s[56:59], s13 offen lds
    v_mfma_f32_16x16x32_bf16 v[100:103], v[200:203], v[180:183], v[100:103]
    s_add_u32 m0, s14, 8192
    s_add_u32 s13, s13, 8192
    buffer_load_dwordx4 v25, s[56:59], s13 offen lds
    v_mfma_f32_16x16x32_bf16 v[104:107], v[204:207], v[176:179], v[104:107]
    v_mfma_f32_16x16x32_bf16 v[108:111], v[204:207], v[180:183], v[108:111]
    v_mfma_f32_16x16x32_bf16 v[112:115], v[208:211], v[176:179], v[112:115]
    s_cmp_eq_u32 s8, 6
    v_mfma_f32_16x16x32_bf16 v[116:119], v[208:211], v[180:183], v[116:119]
    s_cbranch_scc0 L_S2R_13
    v_mfma_f32_16x16x32_bf16 v[128:131], v[176:179], v[176:179], v[128:131]
    v_mfma_f32_16x16x32_bf16 v[132:135], v[180:183], v[180:183], v[132:135]
L_S2R_13:
    s_waitcnt lgkmcnt(0)
    v_mfma_f32_16x16x32_bf16 v[120:123], v[136:139], v[140:143], v[120:123]
    s_waitcnt vmcnt(7)
    ds_read_b64_tr_b16 v[176:177], v10 offset:6144
    v_mfma_f32_16x16x32_bf16 v[124:127], v[136:139], v[144:147], v[124:127]
    ds_read_b64_tr_b16 v[178:179], v10 offset:7168
    ds_read_b64_tr_b16 v[180:181], v11 offset:6144
    v_mfma_f32_16x16x32_bf16 v[64:67], v[148:151], v[140:143], v[64:67]
    ds_read_b64_tr_b16 v[182:183], v11 offset:7168
    ds_read_b64_tr_b16 v[184:185], v9 offset:50176
    v_mfma_f32_16x16x32_bf16 v[68:71], v[148:151], v[144:147], v[68:71]
    ds_read_b64_tr_b16 v[186:187], v9 offset:53760
    ds_read_b64_tr_b16 v[188:189], v9 offset:50208
    v_mfma_f32_16x16x32_bf16 v[72:75], v[152:155], v[140:143], v[72:75]
    ds_read_b64_tr_b16 v[190:191], v9 offset:53792
    ds_read_b64_tr_b16 v[192:193], v9 offset:50240
    v_mfma_f32_16x16x32_bf16 v[76:79], v[152:155], v[144:147], v[76:79]
    ds_read_b64_tr_b16 v[194:195], v9 offset:53824
    ds_read_b64_tr_b16 v[196:197], v9 offset:50272
    v_mfma_f32_16x16x32_bf16 v[80:83], v[156:159], v[140:143], v[80:83]
    ds_read_b64_tr_b16 v[198:199], v9 offset:53856
    ds_read_b64_tr_b16 v[200:201], v9 offset:50304
    v_mfma_f32_16x16x32_bf16 v[84:87], v[156:159], v[144:147], v[84:87]
    ds_read_b64_tr_b16 v[202:203], v9 offset:53888
    ds_read_b64_tr_b16 v[204:205], v9 offset:50336
    v_mfma_f32_16x16x32_bf16 v[88:91], v[160:163], v[140:143], v[88:91]
    ds_read_b64_tr_b16 v[206:207], v9 offset:53920
    ds_read_b64_tr_b16 v[208:209], v9 offset:50368
    v_mfma_f32_16x16x32_bf16 v[92:95], v[160:163], v[144:147], v[92:95]
    ds_read_b64_tr_b16 v[210:211], v9 offset:53952
    v_mfma_f32_16x16x32_bf16 v[96:99], v[164:167], v[140:143], v[96:99]
    s_add_u32 m0, s14, 9216
    s_add_u32 s13, s13, 8192
    buffer_load_dwordx4 v25, s[56:59], s13 offen lds
    s_lshl_b32 s12, s22, 2
    s_add_u32 s12, s12, s3
    s_mul_i32 s4, s12, 112
    v_mfma_f32_16x16x32_bf16 v[100:103], v[164:167], v[144:147], v[100:103]
    s_add_u32 m0, s14, 10240
    s_add_u32 s13, s13, 8192
    buffer_load_dwordx4 v25, s[56:59], s13 offen lds
    s_mul_i32 s5, s23, 7
    s_add_u32 s4, s4, s5
    s_lshl_b32 s4, s4, 10
    v_mfma_f32_16x16x32_bf16 v[104:107], v[168:171], v[140:143], v[104:107]
    s_add_u32 s10, s4, 7340032
    s_add_u32 s11, s10, 4096
    v_mfma_f32_16x16x32_bf16 v[108:111], v[168:171], v[144:147], v[108:111]
    v_mfma_f32_16x16x32_bf16 v[112:115], v[172:175], v[140:143], v[112:115]
    s_cmp_eq_u32 s8, 7
    v_mfma_f32_16x16x32_bf16 v[116:119], v[172:175], v[144:147], v[116:119]
    s_cbranch_scc0 L_S2R_14
    v_mfma_f32_16x16x32_bf16 v[128:131], v[140:143], v[140:143], 0
    v_mfma_f32_16x16x32_bf16 v[132:135], v[144:147], v[144:147], 0
L_S2R_14:
    s_waitcnt lgkmcnt(0)
    v_mfma_f32_16x16x32_bf16 v[120:123], v[136:139], v[176:179], v[120:123]
    v_mfma_f32_16x16x32_bf16 v[124:127], v[136:139], v[180:183], v[124:127]
    v_mfma_f32_16x16x32_bf16 v[64:67], v[184:187], v[176:179], v[64:67]
    v_mfma_f32_16x16x32_bf16 v[68:71], v[184:187], v[180:183], v[68:71]
    v_mfma_f32_16x16x32_bf16 v[72:75], v[188:191], v[176:179], v[72:75]
    v_mfma_f32_16x16x32_bf16 v[76:79], v[188:191], v[180:183], v[76:79]
    s_nop 2
    v_mul_f32 v20, 0x3b000000, v120
    v_mul_f32 v21, 0x3b000000, v124
    v_mfma_f32_16x16x32_bf16 v[80:83], v[192:195], v[176:179], v[80:83]
    v_cvt_pk_bf16_f32 v18, v20, v20
    v_cvt_pk_bf16_f32 v19, v21, v21
    v_mfma_f32_16x16x32_bf16 v[84:87], v[192:195], v[180:183], v[84:87]
    v_and_b32 v18, 0xffff0000, v18
    v_and_b32 v19, 0xffff0000, v19
    v_mfma_f32_16x16x32_bf16 v[88:91], v[196:199], v[176:179], v[88:91]
    v_pk_fma_f32 v[64:65], v[212:213], v[18:19], v[64:65] op_sel:[0,0,0] op_sel_hi:[1,0,1] neg_lo:[0,1,0] neg_hi:[0,1,0]
    v_pk_fma_f32 v[66:67], v[214:215], v[18:19], v[66:67] op_sel:[0,0,0] op_sel_hi:[1,0,1] neg_lo:[0,1,0] neg_hi:[0,1,0]
    v_mfma_f32_16x16x32_bf16 v[92:95], v[196:199], v[180:183], v[92:95]
    v_pk_fma_f32 v[68:69], v[212:213], v[18:19], v[68:69] op_sel:[0,1,0] op_sel_hi:[1,1,1] neg_lo:[0,1,0] neg_hi:[0,1,0]
    v_pk_fma_f32 v[70:71], v[214:215], v[18:19], v[70:71] op_sel:[0,1,0] op_sel_hi:[1,1,1] neg_lo:[0,1,0] neg_hi:[0,1,0]
    v_mfma_f32_16x16x32_bf16 v[96:99], v[200:203], v[176:179], v[96:99]
    s_add_u32 m0, s14, 11264
    s_add_u32 s13, s13, 8192
    buffer_load_dwordx4 v25, s[56:59], s13 offen lds
    v_cvt_pk_bf16_f32 v140, v64, v65
    v_cvt_pk_bf16_f32 v141, v66, v67
    v_mfma_f32_16x16x32_bf16 v[100:103], v[200:203], v[180:183], v[100:103]
    s_add_u32 m0, s14, 12288
    s_add_u32 s13, s13, 8192
    buffer_load_dwordx4 v25, s[56:59], s13 offen lds
    v_cvt_pk_bf16_f32 v142, v68, v69
    v_cvt_pk_bf16_f32 v143, v70, v71
    v_mfma_f32_16x16x32_bf16 v[104:107], v[204:207], v[176:179], v[104:107]
    s_add_u32 m0, s14, 13312
    s_add_u32 s13, s13, 8192
    buffer_load_dwordx4 v25, s[56:59], s13 offen lds
    v_pk_max_i16 v140, v140, 0
    v_pk_max_i16 v141, v141, 0
    v_mfma_f32_16x16x32_bf16 v[108:111], v[204:207], v[180:183], v[108:111]
    v_pk_max_i16 v142, v142, 0
    v_pk_max_i16 v143, v143, 0
    v_mfma_f32_16x16x32_bf16 v[112:115], v[208:211], v[176:179], v[112:115]
    s_cmp_eq_u32 s8, 7
    v_mfma_f32_16x16x32_bf16 v[116:119], v[208:211], v[180:183], v[116:119]
    s_cbranch_scc0 L_S2R_15
    v_mfma_f32_16x16x32_bf16 v[128:131], v[176:179], v[176:179], v[128:131]
    v_mfma_f32_16x16x32_bf16 v[132:135], v[180:183], v[180:183], v[132:135]
L_S2R_15:
    v_pk_fma_f32 v[72:73], v[216:217], v[18:19], v[72:73] op_sel:[0,0,0] op_sel_hi:[1,0,1] neg_lo:[0,1,0] neg_hi:[0,1,0]
    v_pk_fma_f32 v[74:75], v[218:219], v[18:19], v[74:75] op_sel:[0,0,0] op_sel_hi:[1,0,1] neg_lo:[0,1,0] neg_hi:[0,1,0]
    v_permlane16_swap_b32 v140, v142
    v_permlane16_swap_b32 v141, v143
    v_pk_fma_f32 v[76:77], v[216:217], v[18:19], v[76:77] op_sel:[0,1,0] op_sel_hi:[1,1,1] neg_lo:[0,1,0] neg_hi:[0,1,0]
    v_pk_fma_f32 v[78:79], v[218:219], v[18:19], v[78:79] op_sel:[0,1,0] op_sel_hi:[1,1,1] neg_lo:[0,1,0] neg_hi:[0,1,0]
    buffer_store_dwordx4 v[140:143], v5, s[48:51], s10 offen offset:0 sc1
    v_cvt_pk_bf16_f32 v144, v72, v73
    v_cvt_pk_bf16_f32 v145, v74, v75
    v_cvt_pk_bf16_f32 v146, v76, v77
    v_cvt_pk_bf16_f32 v147, v78, v79
    v_pk_max_i16 v144, v144, 0
    v_pk_max_i16 v145, v145, 0
    v_pk_max_i16 v146, v146, 0
    v_pk_max_i16 v147, v147, 0
    v_pk_fma_f32 v[80:81], v[220:221], v[18:19], v[80:81] op_sel:[0,0,0] op_sel_hi:[1,0,1] neg_lo:[0,1,0] neg_hi:[0,1,0]
    v_pk_fma_f32 v[82:83], v[222:223], v[18:19], v[82:83] op_sel:[0,0,0] op_sel_hi:[1,0,1] neg_lo:[0,1,0] neg_hi:[0,1,0]
    v_permlane16_swap_b32 v144, v146
    v_permlane16_swap_b32 v145, v147
    v_pk_fma_f32 v[84:85], v[220:221], v[18:19], v[84:85] op_sel:[0,1,0] op_sel_hi:[1,1,1] neg_lo:[0,1,0] neg_hi:[0,1,0]
    v_pk_fma_f32 v[86:87], v[222:223], v[18:19], v[86:87] op_sel:[0,1,0] op_sel_hi:[1,1,1] neg_lo:[0,1,0] neg_hi:[0,1,0]
    buffer_store_dwordx4 v[144:147], v5, s[48:51], s10 offen offset:1024 sc1
    v_cvt_pk_bf16_f32 v148, v80, v81
    v_cvt_pk_bf16_f32 v149, v82, v83
    v_cvt_pk_bf16_f32 v150, v84, v85
    v_cvt_pk_bf16_f32 v151, v86, v87
    v_pk_max_i16 v148, v148, 0
    v_pk_max_i16 v149, v149, 0
    v_pk_max_i16 v150, v150, 0
    v_pk_max_i16 v151, v151, 0
    v_pk_fma_f32 v[88:89], v[224:225], v[18:19], v[88:89] op_sel:[0,0,0] op_sel_hi:[1,0,1] neg_lo:[0,1,0] neg_hi:[0,1,0]
    v_pk_fma_f32 v[90:91], v[226:227], v[18:19], v[90:91] op_sel:[0,0,0] op_sel_hi:[1,0,1] neg_lo:[0,1,0] neg_hi:[0,1,0]
    v_permlane16_swap_b32 v148, v150
    v_permlane16_swap_b32 v149, v151
    v_pk_fma_f32 v[92:93], v[224:225], v[18:19], v[92:93] op_sel:[0,1,0] op_sel_hi:[1,1,1] neg_lo:[0,1,0] neg_hi:[0,1,0]
    v_pk_fma_f32 v[94:95], v[226:227], v[18:19], v[94:95] op_sel:[0,1,0] op_sel_hi:[1,1,1] neg_lo:[0,1,0] neg_hi:[0,1,0]
    buffer_store_dwordx4 v[148:151], v5, s[48:51], s10 offen offset:2048 sc1
    v_cvt_pk_bf16_f32 v152, v88, v89
    v_cvt_pk_bf16_f32 v153, v90, v91
    v_cvt_pk_bf16_f32 v154, v92, v93
    v_cvt_pk_bf16_f32 v155, v94, v95
    v_pk_max_i16 v152, v152, 0
    v_pk_max_i16 v153, v153, 0
    v_pk_max_i16 v154, v154, 0
    v_pk_max_i16 v155, v155, 0
    v_pk_fma_f32 v[96:97], v[228:229], v[18:19], v[96:97] op_sel:[0,0,0] op_sel_hi:[1,0,1] neg_lo:[0,1,0] neg_hi:[0,1,0]
    v_pk_fma_f32 v[98:99], v[230:231], v[18:19], v[98:99] op_sel:[0,0,0] op_sel_hi:[1,0,1] neg_lo:[0,1,0] neg_hi:[0,1,0]
    v_permlane16_swap_b32 v152, v154
    v_permlane16_swap_b32 v153, v155
    v_pk_fma_f32 v[100:101], v[228:229], v[18:19], v[100:101] op_sel:[0,1,0] op_sel_hi:[1,1,1] neg_lo:[0,1,0] neg_hi:[0,1,0]
    v_pk_fma_f32 v[102:103], v[230:231], v[18:19], v[102:103] op_sel:[0,1,0] op_sel_hi:[1,1,1] neg_lo:[0,1,0] neg_hi:[0,1,0]
    buffer_store_dwordx4 v[152:155], v5, s[48:51], s10 offen offset:3072 sc1
    v_cvt_pk_bf16_f32 v156, v96, v97
    v_cvt_pk_bf16_f32 v157, v98, v99
    v_cvt_pk_bf16_f32 v158, v100, v101
    v_cvt_pk_bf16_f32 v159, v102, v103
    v_pk_max_i16 v156, v156, 0
    v_pk_max_i16 v157, v157, 0
    v_pk_max_i16 v158, v158, 0
    v_pk_max_i16 v159, v159, 0
    v_pk_fma_f32 v[104:105], v[232:233], v[18:19], v[104:105] op_sel:[0,0,0] op_sel_hi:[1,0,1] neg_lo:[0,1,0] neg_hi:[0,1,0]
    v_pk_fma_f32 v[106:107], v[234:235], v[18:19], v[106:107] op_sel:[0,0,0] op_sel_hi:[1,0,1] neg_lo:[0,1,0] neg_hi:[0,1,0]
    v_permlane16_swap_b32 v156, v158
    v_permlane16_swap_b32 v157, v159
    v_pk_fma_f32 v[108:109], v[232:233], v[18:19], v[108:109] op_sel:[0,1,0] op_sel_hi:[1,1,1] neg_lo:[0,1,0] neg_hi:[0,1,0]
    v_pk_fma_f32 v[110:111], v[234:235], v[18:19], v[110:111] op_sel:[0,1,0] op_sel_hi:[1,1,1] neg_lo:[0,1,0] neg_hi:[0,1,0]
    buffer_store_dwordx4 v[156:159], v5, s[48:51], s11 offen offset:0 sc1
    v_cvt_pk_bf16_f32 v160, v104, v105
    v_cvt_pk_bf16_f32 v161, v106, v107
    v_cvt_pk_bf16_f32 v162, v108, v109
    v_cvt_pk_bf16_f32 v163, v110, v111
    v_pk_max_i16 v160, v160, 0
    v_pk_max_i16 v161, v161, 0
    v_pk_max_i16 v162, v162, 0
    v_pk_max_i16 v163, v163, 0
    v_pk_fma_f32 v[112:113], v[236:237], v[18:19], v[112:113] op_sel:[0,0,0] op_sel_hi:[1,0,1] neg_lo:[0,1,0] neg_hi:[0,1,0]
    v_pk_fma_f32 v[114:115], v[238:239], v[18:19], v[114:115] op_sel:[0,0,0] op_sel_hi:[1,0,1] neg_lo:[0,1,0] neg_hi:[0,1,0]
    v_permlane16_swap_b32 v160, v162
    v_permlane16_swap_b32 v161, v163
    v_pk_fma_f32 v[116:117], v[236:237], v[18:19], v[116:117] op_sel:[0,1,0] op_sel_hi:[1,1,1] neg_lo:[0,1,0] neg_hi:[0,1,0]
    v_pk_fma_f32 v[118:119], v[238:239], v[18:19], v[118:119] op_sel:[0,1,0] op_sel_hi:[1,1,1] neg_lo:[0,1,0] neg_hi:[0,1,0]
    buffer_store_dwordx4 v[160:163], v5, s[48:51], s11 offen offset:1024 sc1
    v_cvt_pk_bf16_f32 v164, v112, v113
    v_cvt_pk_bf16_f32 v165, v114, v115
    v_cvt_pk_bf16_f32 v166, v116, v117
    v_cvt_pk_bf16_f32 v167, v118, v119
    v_pk_max_i16 v164, v164, 0
    v_pk_max_i16 v165, v165, 0
    v_pk_max_i16 v166, v166, 0
    v_pk_max_i16 v167, v167, 0
    s_nop 0
    v_permlane16_swap_b32 v164, v166
    v_permlane16_swap_b32 v165, v167
    buffer_store_dwordx4 v[164:167], v5, s[48:51], s11 offen offset:2048 sc1
    s_mov_b32 s8, s12
    s_mov_b32 s28, 0x22222222
    s_mov_b32 s29, s28
    s_mov_b32 s30, 0x44444444
    s_mov_b32 s31, s30
    s_mov_b32 s32, 0x88888888
    s_mov_b32 s33, s32
    s_bitcmp1_b32 s23, 3
    s_cselect_b64 vcc, -1, 0
    v_cndmask_b32 v128, v128, v132, vcc
    v_cndmask_b32 v129, v129, v133, vcc
    v_cndmask_b32 v130, v130, v134, vcc
    v_cndmask_b32 v131, v131, v135, vcc
    v_cndmask_b32 v22, v120, v124, vcc
    v_cndmask_b32 v23, v20, v21, vcc
    v_cndmask_b32 v24, v128, v129, s[28:29]
    v_mul_f32 v22, 0xbe000000, v22
    v_cndmask_b32 v24, v24, v130, s[30:31]
    v_and_b32 v13, 15, v1
    v_cndmask_b32 v24, v24, v131, s[32:33]
    v_lshlrev_b32 v13, 2, v13
    v_fmac_f32 v24, v22, v23
    s_lshl_b32 s9, s8, 10
    s_and_b32 s5, s23, 7
    s_lshl_b32 s5, s5, 7
    s_add_u32 s9, s9, s5
    s_lshr_b32 s5, s23, 3
    s_lshl_b32 s5, s5, 6
    s_add_u32 s9, s9, s5
    s_add_u32 s9, s9, 344064
    s_mov_b32 exec_lo, 0x00F0000F
    s_mov_b32 exec_hi, 0xF0000F00
    buffer_store_dword v24, v13, s[48:51], s9 offen sc1
    s_mov_b64 exec, -1
    s_barrier
    s_lshl_b32 s12, s24, 16
    s_lshl_b32 s5, s25, 12
    s_add_u32 s12, s12, s5
    s_and_b32 s5, s3, 1
    s_lshl_b32 s5, s5, 11
    s_add_u32 s12, s12, s5
    s_lshr_b32 s5, s3, 1
    s_lshl_b32 s5, s5, 10
    s_add_u32 s12, s12, s5
    s_add_u32 s12, s12, 5242880
    s_add_u32 s9, s12, 32768 - 1024
    s_mov_b32 m0, s21
    s_nop 0
    buffer_load_dwordx4 v5, s[48:51], s12 offen sc1 lds
    buffer_load_dwordx4 v5, s[48:51], s9 offen offset:1024 sc1 lds
    s_add_u32 s34, s14, 57344
    s_add_u32 s35, s21, 2048
    s_add_u32 m0, s34, 0
    s_add_u32 s13, s13, 8192
    buffer_load_dwordx4 v25, s[56:59], s13 offen lds
    s_add_u32 m0, s34, 1024
    s_add_u32 s13, s13, 8192
    buffer_load_dwordx4 v25, s[56:59], s13 offen lds
    s_add_u32 m0, s34, 2048
    s_add_u32 s13, s13, 8192
    buffer_load_dwordx4 v25, s[56:59], s13 offen lds
    s_add_u32 m0, s34, 3072
    s_add_u32 s13, s13, 8192
    buffer_load_dwordx4 v25, s[56:59], s13 offen lds
    s_add_u32 m0, s34, 4096
    s_add_u32 s13, s13, 8192
    buffer_load_dwordx4 v25, s[56:59], s13 offen lds
    s_add_u32 m0, s34, 5120
    s_add_u32 s13, s13, 8192
    buffer_load_dwordx4 v25, s[56:59], s13 offen lds
    s_add_u32 m0, s34, 6144
    s_add_u32 s13, s13, 8192
    buffer_load_dwordx4 v25, s[56:59], s13 offen lds
    s_add_u32 m0, s34, 7168
    s_add_u32 s13, s13, 8192
    buffer_load_dwordx4 v25, s[56:59], s13 offen lds
    v_add_u32 v27, s14, v26
    v_xor_b32 v28, 64, v27
    s_waitcnt vmcnt(18)
    ds_read_b64_tr_b16 a[24:25], v27 offset:0
    ds_read_b64_tr_b16 a[26:27], v27 offset:512
    ds_read_b64_tr_b16 a[28:29], v28 offset:0
    ds_read_b64_tr_b16 a[30:31], v28 offset:512
    ds_read_b64_tr_b16 a[32:33], v27 offset:2048
    ds_read_b64_tr_b16 a[34:35], v27 offset:2560
    ds_read_b64_tr_b16 a[36:37], v28 offset:2048
    ds_read_b64_tr_b16 a[38:39], v28 offset:2560
    ds_read_b64_tr_b16 a[40:41], v27 offset:4096
    ds_read_b64_tr_b16 a[42:43], v27 offset:4608
    ds_read_b64_tr_b16 a[44:45], v28 offset:4096
    ds_read_b64_tr_b16 a[46:47], v28 offset:4608
    ds_read_b64_tr_b16 a[48:49], v27 offset:6144
    ds_read_b64_tr_b16 a[50:51], v27 offset:6656
    ds_read_b64_tr_b16 a[52:53], v28 offset:6144
    ds_read_b64_tr_b16 a[54:55], v28 offset:6656
    ds_read_b64_tr_b16 a[56:57], v27 offset:8192
    ds_read_b64_tr_b16 a[58:59], v27 offset:8704
    ds_read_b64_tr_b16 a[60:61], v28 offset:8192
    ds_read_b64_tr_b16 a[62:63], v28 offset:8704
    ds_read_b64_tr_b16 a[64:65], v27 offset:10240
    ds_read_b64_tr_b16 a[66:67], v27 offset:10752
    ds_read_b64_tr_b16 a[68:69], v28 offset:10240
    ds_read_b64_tr_b16 a[70:71], v28 offset:10752
    ds_read_b64_tr_b16 a[72:73], v27 offset:12288
    ds_read_b64_tr_b16 a[74:75], v27 offset:12800
    ds_read_b64_tr_b16 a[76:77], v28 offset:12288
    ds_read_b64_tr_b16 a[78:79], v28 offset:12800
    s_lshl_b32 s4, s22, 4
    s_add_u32 s4, s4, s23
    s_lshl_b32 s4, s4, 2
    s_add_u32 s4, s4, s3
    s_lshl_b32 s4, s4, 7
    s_add_u32 s4, s4, 163840
    s_lshr_b32 s11, s24, 1
    s_lshl_b32 s11, s11, 6
    s_lshl_b32 s5, s3, 4
    s_add_u32 s11, s11, s5
    s_and_b32 s5, s24, 1
    s_lshl_b32 s5, s5, 1
    s_add_u32 s11, s11, s5
    s_lshl_b32 s11, s11, 7
    s_add_u32 s11, s11, 163840
    v_and_b32 v24, 3, v1
    v_lshlrev_b32 v24, 9, v24
    v_bfe_u32 v22, v1, 2, 1
    v_lshl_add_u32 v24, v22, 7, v24
    v_add_u32 v24, s11, v24
    v_lshlrev_b32 v23, 7, v1
    s_waitcnt vmcnt(10)
    s_mov_b64 exec, 1
    buffer_store_dword v250, v251, s[48:51], s4 offen sc1
    s_mov_b64 exec, -1
    s_add_u32 m0, s34, 8192
    s_add_u32 s13, s13, 8192
    buffer_load_dwordx4 v25, s[56:59], s13 offen lds
    s_add_u32 m0, s34, 9216
    s_add_u32 s13, s13, 8192
    buffer_load_dwordx4 v25, s[56:59], s13 offen lds
    s_add_u32 m0, s34, 10240
    s_add_u32 s13, s13, 8192
    buffer_load_dwordx4 v25, s[56:59], s13 offen lds
    s_add_u32 m0, s34, 11264
    s_add_u32 s13, s13, 8192
    buffer_load_dwordx4 v25, s[56:59], s13 offen lds
    s_add_u32 m0, s34, 12288
    s_add_u32 s13, s13, 8192
    buffer_load_dwordx4 v25, s[56:59], s13 offen lds
    s_add_u32 m0, s34, 13312
    s_add_u32 s13, s13, 8192
    buffer_load_dwordx4 v25, s[56:59], s13 offen lds
    s_add_u32 m0, s35, 0
    s_add_u32 s13, s13, 8192
    buffer_load_dwordx4 v25, s[56:59], s13 offen lds
    s_add_u32 m0, s35, 1024
    s_add_u32 s13, s13, 8192
    buffer_load_dwordx4 v25, s[56:59], s13 offen lds
    s_add_u32 m0, s35, 2048
    s_add_u32 s13, s13, 8192
    buffer_load_dwordx4 v25, s[56:59], s13 offen lds
    s_add_u32 m0, s35, 3072
    s_add_u32 s13, s13, 8192
    buffer_load_dwordx4 v25, s[56:59], s13 offen lds
    s_add_u32 m0, s35, 4096
    s_add_u32 s13, s13, 8192
    buffer_load_dwordx4 v25, s[56:59], s13 offen lds
    s_add_u32 m0, s35, 5120
    s_add_u32 s13, s13, 8192
    buffer_load_dwordx4 v25, s[56:59], s13 offen lds
    s_add_u32 m0, s35, 6144
    s_add_u32 s13, s13, 8192
    buffer_load_dwordx4 v25, s[56:59], s13 offen lds
    s_add_u32 m0, s35, 7168
    s_add_u32 s13, s13, 8192
    buffer_load_dwordx4 v25, s[56:59], s13 offen lds
    s_waitcnt lgkmcnt(0)
    s_add_u32 m0, s14, 0
    s_add_u32 s13, s13, 8192
    buffer_load_dwordx4 v25, s[56:59], s13 offen lds
    s_add_u32 m0, s14, 1024
    s_add_u32 s13, s13, 8192
    buffer_load_dwordx4 v25, s[56:59], s13 offen lds
    s_add_u32 m0, s14, 2048
    s_add_u32 s13, s13, 8192
    buffer_load_dwordx4 v25, s[56:59], s13 offen lds
    s_add_u32 m0, s14, 3072
    s_add_u32 s13, s13, 8192
    buffer_load_dwordx4 v25, s[56:59], s13 offen lds
    s_add_u32 m0, s14, 4096
    s_add_u32 s13, s13, 8192
    buffer_load_dwordx4 v25, s[56:59], s13 offen lds
    s_add_u32 m0, s14, 5120
    s_add_u32 s13, s13, 8192
    buffer_load_dwordx4 v25, s[56:59], s13 offen lds
    s_add_u32 m0, s14, 6144
    s_add_u32 s13, s13, 8192
    buffer_load_dwordx4 v25, s[56:59], s13 offen lds
    s_add_u32 m0, s14, 7168
    s_add_u32 s13, s13, 8192
    buffer_load_dwordx4 v25, s[56:59], s13 offen lds
    s_add_u32 m0, s14, 8192
    s_add_u32 s13, s13, 8192
    buffer_load_dwordx4 v25, s[56:59], s13 offen lds
    s_add_u32 m0, s14, 9216
    s_add_u32 s13, s13, 8192
    buffer_load_dwordx4 v25, s[56:59], s13 offen lds
    s_add_u32 m0, s14, 10240
    s_add_u32 s13, s13, 8192
    buffer_load_dwordx4 v25, s[56:59], s13 offen lds
    s_add_u32 m0, s14, 11264
    s_add_u32 s13, s13, 8192
    buffer_load_dwordx4 v25, s[56:59], s13 offen lds
    s_add_u32 m0, s14, 12288
    s_add_u32 s13, s13, 8192
    buffer_load_dwordx4 v25, s[56:59], s13 offen lds
    s_add_u32 m0, s14, 13312
    s_add_u32 s13, s13, 8192
    buffer_load_dwordx4 v25, s[56:59], s13 offen lds
    s_or_b32 s4, s2, s3
    s_cmp_lg_u32 s4, 0
    s_cbranch_scc1 L_NE
    s_mov_b32 s4, 0
    s_mov_b64 exec, 1
    buffer_store_dword v250, v251, s[48:51], s4 offen sc1
    s_mov_b64 exec, -1
L_NE:
    s_mul_i32 s4, s24, 229376
    s_mul_i32 s5, s3, 28672
    s_add_u32 s5, s5, 7340032
    s_add_u32 s32, s4, s5
    s_add_u32 s33, s32, 114688
    v_lshrrev_b32 v16, 5, v1
    v_lshlrev_b32 v16, 10, v16
    v_and_b32 v17, 15, v1
    v_lshl_add_u32 v16, v17, 2, v16
    v_bfe_u32 v18, v1, 4, 1
    v_lshl_add_u32 v16, v18, 8, v16
    s_lshl_b32 s40, s24, 11
    s_and_b32 s5, s3, 1
    s_lshl_b32 s5, s5, 9
    s_add_u32 s40, s40, s5
    s_lshr_b32 s5, s3, 1
    s_lshl_b32 s5, s5, 6
    s_add_u32 s40, s40, s5
    s_add_u32 s40, s40, 344064
    s_lshl_b32 s4, s3, 14
    v_add_u32 v8, s4, v5
    s_lshl_b32 s4, s3, 8
    s_add_u32 s4, s4, 124928
    v_lshl_add_u32 v9, v1, 2, s4
    v_lshlrev_b32 v11, 2, v17
    v_lshl_add_u32 v11, v18, 9, v11
    v_add_u32 v11, 124928, v11
    s_and_b32 s4, s3, 1
    s_lshl_b32 s4, s4, 12
    s_lshr_b32 s5, s3, 1
    s_lshl_b32 s5, s5, 11
    s_add_u32 s4, s4, s5
    v_add_u32 v12, s4, v5
    v_lshrrev_b32 v13, 5, v1
    v_lshlrev_b32 v13, 2, v13
    v_bfe_u32 v14, v1, 2, 2
    v_add_u32 v13, v13, v14
    v_lshlrev_b32 v13, 6, v13
    v_lshl_add_u32 v13, v18, 5, v13
    v_and_b32 v14, 3, v1
    v_lshl_add_u32 v13, v14, 3, v13
    v_add_u32 v13, s21, v13
    v_and_b32 v10, 31, v1
    v_lshlrev_b32 v10, 10, v10
    v_lshrrev_b32 v14, 5, v1
    v_lshl_add_u32 v10, v14, 4, v10
    s_lshl_b32 s4, s24, 16
    s_lshl_b32 s5, s25, 7
    s_add_u32 s4, s4, s5
    s_and_b32 s5, s3, 1
    s_lshl_b32 s5, s5, 6
    s_add_u32 s4, s4, s5
    s_lshr_b32 s5, s3, 1
    s_lshl_b32 s5, s5, 5
    s_add_u32 s38, s4, s5
    s_add_u32 s39, s38, 32768
    v_add_u32 v29, s34, v26
    v_xor_b32 v30, 64, v29
    s_waitcnt vmcnt(22)
    ds_read_b64_tr_b16 a[80:81], v29 offset:0
    ds_read_b64_tr_b16 a[82:83], v29 offset:512
    ds_read_b64_tr_b16 a[84:85], v30 offset:0
    ds_read_b64_tr_b16 a[86:87], v30 offset:512
    ds_read_b64_tr_b16 a[88:89], v29 offset:2048
    ds_read_b64_tr_b16 a[90:91], v29 offset:2560
    ds_read_b64_tr_b16 a[92:93], v30 offset:2048
    ds_read_b64_tr_b16 a[94:95], v30 offset:2560
    ds_read_b64_tr_b16 a[96:97], v29 offset:4096
    ds_read_b64_tr_b16 a[98:99], v29 offset:4608
    ds_read_b64_tr_b16 a[100:101], v30 offset:4096
    ds_read_b64_tr_b16 a[102:103], v30 offset:4608
    ds_read_b64_tr_b16 a[104:105], v29 offset:6144
    ds_read_b64_tr_b16 a[106:107], v29 offset:6656
    ds_read_b64_tr_b16 a[108:109], v30 offset:6144
    ds_read_b64_tr_b16 a[110:111], v30 offset:6656
    ds_read_b64_tr_b16 a[112:113], v29 offset:8192
    ds_read_b64_tr_b16 a[114:115], v29 offset:8704
    ds_read_b64_tr_b16 a[116:117], v30 offset:8192
    ds_read_b64_tr_b16 a[118:119], v30 offset:8704
    ds_read_b64_tr_b16 a[120:121], v29 offset:10240
    ds_read_b64_tr_b16 a[122:123], v29 offset:10752
    ds_read_b64_tr_b16 a[124:125], v30 offset:10240
    ds_read_b64_tr_b16 a[126:127], v30 offset:10752
    ds_read_b64_tr_b16 a[128:129], v29 offset:12288
    ds_read_b64_tr_b16 a[130:131], v29 offset:12800
    ds_read_b64_tr_b16 a[132:133], v30 offset:12288
    ds_read_b64_tr_b16 a[134:135], v30 offset:12800
    buffer_load_dword v31, v24, s[48:51], 0 offen sc1
    buffer_load_dword v4, v23, s[48:51], s32 offen sc1
    v_add_u32 v21, s35, v26
    v_xor_b32 v22, 64, v21
    s_waitcnt vmcnt(16)
    ds_read_b64_tr_b16 a[136:137], v21 offset:0
    ds_read_b64_tr_b16 a[138:139], v21 offset:512
    ds_read_b64_tr_b16 a[140:141], v22 offset:0
    ds_read_b64_tr_b16 a[142:143], v22 offset:512
    ds_read_b64_tr_b16 a[144:145], v21 offset:2048
    ds_read_b64_tr_b16 a[146:147], v21 offset:2560
    ds_read_b64_tr_b16 a[148:149], v22 offset:2048
    ds_read_b64_tr_b16 a[150:151], v22 offset:2560
    ds_read_b64_tr_b16 a[152:153], v21 offset:4096
    ds_read_b64_tr_b16 a[154:155], v21 offset:4608
    ds_read_b64_tr_b16 a[156:157], v22 offset:4096
    ds_read_b64_tr_b16 a[158:159], v22 offset:4608
    ds_read_b64_tr_b16 a[160:161], v21 offset:6144
    ds_read_b64_tr_b16 a[162:163], v21 offset:6656
    ds_read_b64_tr_b16 a[164:165], v22 offset:6144
    ds_read_b64_tr_b16 a[166:167], v22 offset:6656
    s_mov_b32 s19, 0
    s_waitcnt vmcnt(1)
    s_branch PCHK_15
POLL_13:
    s_mov_b64 exec, vcc
    buffer_load_dword v31, v24, s[48:51], 0 offen sc1
    s_add_u32 s19, s19, 1
    s_waitcnt vmcnt(0)
PCHK_15:
    v_cmp_ne_u32 vcc, s18, v31
    s_cbranch_vccz PDONE_14
    s_cmp_lt_u32 s19, 65536
    s_cbranch_scc1 POLL_13
PDONE_14:
    s_mov_b64 exec, -1
    buffer_load_dword v22, v16, s[48:51], s40 offen sc1
    buffer_load_dword v23, v16, s[48:51], s40 offen offset:128 sc1
    s_add_u32 s37, s32, 0
    buffer_load_dwordx4 v[32:35], v5, s[48:51], s37 offen offset:0 sc1
    buffer_load_dwordx4 v[36:39], v5, s[48:51], s37 offen offset:1024 sc1
    buffer_load_dwordx4 v[40:43], v5, s[48:51], s37 offen offset:2048 sc1
    buffer_load_dwordx4 v[44:47], v5, s[48:51], s37 offen offset:3072 sc1
    s_add_u32 s37, s32, 4096
    buffer_load_dwordx4 v[48:51], v5, s[48:51], s37 offen offset:0 sc1
    buffer_load_dwordx4 v[52:55], v5, s[48:51], s37 offen offset:1024 sc1
    buffer_load_dwordx4 v[56:59], v5, s[48:51], s37 offen offset:2048 sc1
    buffer_load_dwordx4 v[60:63], v5, s[48:51], s37 offen offset:3072 sc1
    ds_read_b64_tr_b16 a[168:169], v27 offset:0
    ds_read_b64_tr_b16 a[170:171], v27 offset:512
    ds_read_b64_tr_b16 a[172:173], v28 offset:0
    ds_read_b64_tr_b16 a[174:175], v28 offset:512
    ds_read_b64_tr_b16 a[176:177], v27 offset:2048
    ds_read_b64_tr_b16 a[178:179], v27 offset:2560
    ds_read_b64_tr_b16 a[180:181], v28 offset:2048
    ds_read_b64_tr_b16 a[182:183], v28 offset:2560
    ds_read_b64_tr_b16 a[184:185], v27 offset:4096
    ds_read_b64_tr_b16 a[186:187], v27 offset:4608
    ds_read_b64_tr_b16 a[188:189], v28 offset:4096
    ds_read_b64_tr_b16 a[190:191], v28 offset:4608
    ds_read_b64_tr_b16 a[192:193], v27 offset:6144
    ds_read_b64_tr_b16 a[194:195], v27 offset:6656
    ds_read_b64_tr_b16 a[196:197], v28 offset:6144
    ds_read_b64_tr_b16 a[198:199], v28 offset:6656
    ds_read_b64_tr_b16 a[200:201], v27 offset:8192
    ds_read_b64_tr_b16 a[202:203], v27 offset:8704
    ds_read_b64_tr_b16 a[204:205], v28 offset:8192
    ds_read_b64_tr_b16 a[206:207], v28 offset:8704
    ds_read_b64_tr_b16 a[208:209], v27 offset:10240
    ds_read_b64_tr_b16 a[210:211], v27 offset:10752
    ds_read_b64_tr_b16 a[212:213], v28 offset:10240
    ds_read_b64_tr_b16 a[214:215], v28 offset:10752
    ds_read_b64_tr_b16 a[216:217], v27 offset:12288
    ds_read_b64_tr_b16 a[218:219], v27 offset:12800
    ds_read_b64_tr_b16 a[220:221], v28 offset:12288
    ds_read_b64_tr_b16 a[222:223], v28 offset:12800
    s_waitcnt lgkmcnt(0)
    ds_read_b64_tr_b16 v[176:177], v13 offset:0
    ds_read_b64_tr_b16 v[178:179], v13 offset:512
    ds_read_b64_tr_b16 v[180:181], v13 offset:1024
    ds_read_b64_tr_b16 v[182:183], v13 offset:1536
    s_waitcnt vmcnt(7)
    v_mfma_f32_32x32x16_bf16 a[224:239], a[0:3], v[32:35], 0
    s_add_u32 s37, s32, 8192
    buffer_load_dwordx4 v[64:67], v5, s[48:51], s37 offen offset:0 sc1
    v_add_f32 v22, v22, v23
    v_mfma_f32_32x32x16_bf16 a[240:255], a[4:7], v[32:35], 0
    ds_write_b32 v9, v22
    s_waitcnt vmcnt(7)
    v_mfma_f32_32x32x16_bf16 a[224:239], a[8:11], v[36:39], a[224:239]
    buffer_load_dwordx4 v[68:71], v5, s[48:51], s37 offen offset:1024 sc1
    v_mfma_f32_32x32x16_bf16 a[240:255], a[12:15], v[36:39], a[240:255]
    s_waitcnt vmcnt(7)
    v_mfma_f32_32x32x16_bf16 a[224:239], a[16:19], v[40:43], a[224:239]
    buffer_load_dwordx4 v[32:35], v5, s[48:51], s37 offen offset:2048 sc1
    s_waitcnt lgkmcnt(0)
    v_lshlrev_b32 v160, 16, v176
    v_and_b32 v161, 0xffff0000, v176
    v_lshlrev_b32 v162, 16, v177
    v_and_b32 v163, 0xffff0000, v177
    v_mfma_f32_32x32x16_bf16 a[240:255], a[20:23], v[40:43], a[240:255]
    v_lshlrev_b32 v164, 16, v178
    v_and_b32 v165, 0xffff0000, v178
    v_lshlrev_b32 v166, 16, v179
    v_and_b32 v167, 0xffff0000, v179
    s_waitcnt vmcnt(7)
    v_mfma_f32_32x32x16_bf16 a[224:239], a[24:27], v[44:47], a[224:239]
    buffer_load_dwordx4 v[36:39], v5, s[48:51], s37 offen offset:3072 sc1
    v_lshlrev_b32 v168, 16, v180
    v_and_b32 v169, 0xffff0000, v180
    v_lshlrev_b32 v170, 16, v181
    v_and_b32 v171, 0xffff0000, v181
    v_mfma_f32_32x32x16_bf16 a[240:255], a[28:31], v[44:47], a[240:255]
    v_lshlrev_b32 v172, 16, v182
    v_and_b32 v173, 0xffff0000, v182
    v_lshlrev_b32 v174, 16, v183
    v_and_b32 v175, 0xffff0000, v183
    s_waitcnt vmcnt(7)
    v_mfma_f32_32x32x16_bf16 a[224:239], a[32:35], v[48:51], a[224:239]
    s_add_u32 s37, s32, 12288
    buffer_load_dwordx4 v[40:43], v5, s[48:51], s37 offen offset:0 sc1
    v_mfma_f32_32x32x16_bf16 a[240:255], a[36:39], v[48:51], a[240:255]
    s_waitcnt vmcnt(7)
    v_mfma_f32_32x32x16_bf16 a[224:239], a[40:43], v[52:55], a[224:239]
    buffer_load_dwordx4 v[44:47], v5, s[48:51], s37 offen offset:1024 sc1
    v_mfma_f32_32x32x16_bf16 a[240:255], a[44:47], v[52:55], a[240:255]
    s_waitcnt vmcnt(7)
    v_mfma_f32_32x32x16_bf16 a[224:239], a[48:51], v[56:59], a[224:239]
    buffer_load_dwordx4 v[48:51], v5, s[48:51], s37 offen offset:2048 sc1
    v_mfma_f32_32x32x16_bf16 a[240:255], a[52:55], v[56:59], a[240:255]
    s_waitcnt vmcnt(7)
    v_mfma_f32_32x32x16_bf16 a[224:239], a[56:59], v[60:63], a[224:239]
    buffer_load_dwordx4 v[52:55], v5, s[48:51], s37 offen offset:3072 sc1
    v_mfma_f32_32x32x16_bf16 a[240:255], a[60:63], v[60:63], a[240:255]
    s_waitcnt vmcnt(7)
    v_mfma_f32_32x32x16_bf16 a[224:239], a[64:67], v[64:67], a[224:239]
    s_add_u32 s37, s32, 16384
    buffer_load_dwordx4 v[56:59], v5, s[48:51], s37 offen offset:0 sc1
    v_mfma_f32_32x32x16_bf16 a[240:255], a[68:71], v[64:67], a[240:255]
    s_waitcnt vmcnt(7)
    v_mfma_f32_32x32x16_bf16 a[224:239], a[72:75], v[68:71], a[224:239]
    buffer_load_dwordx4 v[60:63], v5, s[48:51], s37 offen offset:1024 sc1
    v_mfma_f32_32x32x16_bf16 a[240:255], a[76:79], v[68:71], a[240:255]
    s_waitcnt vmcnt(7)
    v_mfma_f32_32x32x16_bf16 a[224:239], a[80:83], v[32:35], a[224:239]
    buffer_load_dwordx4 v[64:67], v5, s[48:51], s37 offen offset:2048 sc1
    v_mfma_f32_32x32x16_bf16 a[240:255], a[84:87], v[32:35], a[240:255]
    s_waitcnt vmcnt(7)
    v_mfma_f32_32x32x16_bf16 a[224:239], a[88:91], v[36:39], a[224:239]
    buffer_load_dwordx4 v[68:71], v5, s[48:51], s37 offen offset:3072 sc1
    v_mfma_f32_32x32x16_bf16 a[240:255], a[92:95], v[36:39], a[240:255]
    s_waitcnt vmcnt(7)
    v_mfma_f32_32x32x16_bf16 a[224:239], a[96:99], v[40:43], a[224:239]
    s_add_u32 s37, s32, 20480
    buffer_load_dwordx4 v[32:35], v5, s[48:51], s37 offen offset:0 sc1
    v_mfma_f32_32x32x16_bf16 a[240:255], a[100:103], v[40:43], a[240:255]
    s_waitcnt vmcnt(7)
    v_mfma_f32_32x32x16_bf16 a[224:239], a[104:107], v[44:47], a[224:239]
    buffer_load_dwordx4 v[36:39], v5, s[48:51], s37 offen offset:1024 sc1
    v_mfma_f32_32x32x16_bf16 a[240:255], a[108:111], v[44:47], a[240:255]
    s_waitcnt vmcnt(7)
    v_mfma_f32_32x32x16_bf16 a[224:239], a[112:115], v[48:51], a[224:239]
    buffer_load_dwordx4 v[40:43], v5, s[48:51], s37 offen offset:2048 sc1
    v_mfma_f32_32x32x16_bf16 a[240:255], a[116:119], v[48:51], a[240:255]
    s_waitcnt vmcnt(7)
    v_mfma_f32_32x32x16_bf16 a[224:239], a[120:123], v[52:55], a[224:239]
    buffer_load_dwordx4 v[44:47], v5, s[48:51], s37 offen offset:3072 sc1
    v_mfma_f32_32x32x16_bf16 a[240:255], a[124:127], v[52:55], a[240:255]
    s_waitcnt vmcnt(7)
    v_mfma_f32_32x32x16_bf16 a[224:239], a[128:131], v[56:59], a[224:239]
    s_add_u32 s37, s32, 24576
    buffer_load_dwordx4 v[48:51], v5, s[48:51], s37 offen offset:0 sc1
    v_mfma_f32_32x32x16_bf16 a[240:255], a[132:135], v[56:59], a[240:255]
    s_waitcnt vmcnt(7)
    v_mfma_f32_32x32x16_bf16 a[224:239], a[136:139], v[60:63], a[224:239]
    buffer_load_dwordx4 v[52:55], v5, s[48:51], s37 offen offset:1024 sc1
    v_mfma_f32_32x32x16_bf16 a[240:255], a[140:143], v[60:63], a[240:255]
    s_waitcnt vmcnt(7)
    v_mfma_f32_32x32x16_bf16 a[224:239], a[144:147], v[64:67], a[224:239]
    buffer_load_dwordx4 v[56:59], v5, s[48:51], s37 offen offset:2048 sc1
    v_mfma_f32_32x32x16_bf16 a[240:255], a[148:151], v[64:67], a[240:255]
    s_waitcnt vmcnt(7)
    v_mfma_f32_32x32x16_bf16 a[224:239], a[152:155], v[68:71], a[224:239]
    buffer_load_dwordx4 v[60:63], v5, s[48:51], s37 offen offset:3072 sc1
    v_mfma_f32_32x32x16_bf16 a[240:255], a[156:159], v[68:71], a[240:255]
    s_waitcnt vmcnt(7)
    v_mfma_f32_32x32x16_bf16 a[224:239], a[160:163], v[32:35], a[224:239]
    s_add_u32 s37, s33, 0
    buffer_load_dwordx4 v[64:67], v5, s[48:51], s37 offen offset:0 sc1
    v_mfma_f32_32x32x16_bf16 a[240:255], a[164:167], v[32:35], a[240:255]
    s_barrier
    s_waitcnt vmcnt(7)
    v_mfma_f32_32x32x16_bf16 a[224:239], a[168:171], v[36:39], a[224:239]
    buffer_load_dwordx4 v[68:71], v5, s[48:51], s37 offen offset:1024 sc1
    v_mfma_f32_32x32x16_bf16 a[240:255], a[172:175], v[36:39], a[240:255]
    s_waitcnt vmcnt(7)
    v_mfma_f32_32x32x16_bf16 a[224:239], a[176:179], v[40:43], a[224:239]
    buffer_load_dwordx4 v[32:35], v5, s[48:51], s37 offen offset:2048 sc1
    v_mfma_f32_32x32x16_bf16 a[240:255], a[180:183], v[40:43], a[240:255]
    s_waitcnt vmcnt(7)
    v_mfma_f32_32x32x16_bf16 a[224:239], a[184:187], v[44:47], a[224:239]
    buffer_load_dwordx4 v[36:39], v5, s[48:51], s37 offen offset:3072 sc1
    v_mfma_f32_32x32x16_bf16 a[240:255], a[188:191], v[44:47], a[240:255]
    s_waitcnt vmcnt(7)
    v_mfma_f32_32x32x16_bf16 a[224:239], a[192:195], v[48:51], a[224:239]
    s_add_u32 s37, s33, 4096
    buffer_load_dwordx4 v[40:43], v5, s[48:51], s37 offen offset:0 sc1
    v_mfma_f32_32x32x16_bf16 a[240:255], a[196:199], v[48:51], a[240:255]
    s_waitcnt vmcnt(7)
    v_mfma_f32_32x32x16_bf16 a[224:239], a[200:203], v[52:55], a[224:239]
    buffer_load_dwordx4 v[44:47], v5, s[48:51], s37 offen offset:1024 sc1
    v_mfma_f32_32x32x16_bf16 a[240:255], a[204:207], v[52:55], a[240:255]
    s_waitcnt vmcnt(7)
    v_mfma_f32_32x32x16_bf16 a[224:239], a[208:211], v[56:59], a[224:239]
    buffer_load_dwordx4 v[48:51], v5, s[48:51], s37 offen offset:2048 sc1
    v_mfma_f32_32x32x16_bf16 a[240:255], a[212:215], v[56:59], a[240:255]
    s_waitcnt vmcnt(7)
    v_mfma_f32_32x32x16_bf16 a[224:239], a[216:219], v[60:63], a[224:239]
    buffer_load_dwordx4 v[52:55], v5, s[48:51], s37 offen offset:3072 sc1
    v_mfma_f32_32x32x16_bf16 a[240:255], a[220:223], v[60:63], a[240:255]
    s_waitcnt vmcnt(7)
    v_mfma_f32_32x32x16_bf16 v[224:239], a[0:3], v[64:67], 0
    s_add_u32 s37, s33, 8192
    buffer_load_dwordx4 v[56:59], v5, s[48:51], s37 offen offset:0 sc1
    v_mfma_f32_32x32x16_bf16 v[240:255], a[4:7], v[64:67], 0
    s_waitcnt vmcnt(7)
    v_mfma_f32_32x32x16_bf16 v[224:239], a[8:11], v[68:71], v[224:239]
    buffer_load_dwordx4 v[60:63], v5, s[48:51], s37 offen offset:1024 sc1
    s_nop 1
    ds_write_b128 v8, a[224:227] offset:0
    v_mfma_f32_32x32x16_bf16 v[240:255], a[12:15], v[68:71], v[240:255]
    s_waitcnt vmcnt(7)
    v_mfma_f32_32x32x16_bf16 v[224:239], a[16:19], v[32:35], v[224:239]
    buffer_load_dwordx4 v[64:67], v5, s[48:51], s37 offen offset:2048 sc1
    ds_write_b128 v8, a[228:231] offset:1024
    v_mfma_f32_32x32x16_bf16 v[240:255], a[20:23], v[32:35], v[240:255]
    s_waitcnt vmcnt(7)
    v_mfma_f32_32x32x16_bf16 v[224:239], a[24:27], v[36:39], v[224:239]
    buffer_load_dwordx4 v[68:71], v5, s[48:51], s37 offen offset:3072 sc1
    ds_write_b128 v8, a[232:235] offset:2048
    v_mfma_f32_32x32x16_bf16 v[240:255], a[28:31], v[36:39], v[240:255]
    s_waitcnt vmcnt(7)
    v_mfma_f32_32x32x16_bf16 v[224:239], a[32:35], v[40:43], v[224:239]
    s_add_u32 s37, s33, 12288
    buffer_load_dwordx4 v[32:35], v5, s[48:51], s37 offen offset:0 sc1
    ds_write_b128 v8, a[236:239] offset:3072
    v_mfma_f32_32x32x16_bf16 v[240:255], a[36:39], v[40:43], v[240:255]
    s_waitcnt vmcnt(7)
    v_mfma_f32_32x32x16_bf16 v[224:239], a[40:43], v[44:47], v[224:239]
    buffer_load_dwordx4 v[36:39], v5, s[48:51], s37 offen offset:1024 sc1
    ds_write_b128 v8, a[240:243] offset:4096
    v_mfma_f32_32x32x16_bf16 v[240:255], a[44:47], v[44:47], v[240:255]
    s_waitcnt vmcnt(7)
    v_mfma_f32_32x32x16_bf16 v[224:239], a[48:51], v[48:51], v[224:239]
    buffer_load_dwordx4 v[40:43], v5, s[48:51], s37 offen offset:2048 sc1
    ds_write_b128 v8, a[244:247] offset:5120
    v_mfma_f32_32x32x16_bf16 v[240:255], a[52:55], v[48:51], v[240:255]
    s_waitcnt vmcnt(7)
    v_mfma_f32_32x32x16_bf16 v[224:239], a[56:59], v[52:55], v[224:239]
    buffer_load_dwordx4 v[44:47], v5, s[48:51], s37 offen offset:3072 sc1
    ds_write_b128 v8, a[248:251] offset:6144
    v_mfma_f32_32x32x16_bf16 v[240:255], a[60:63], v[52:55], v[240:255]
    s_waitcnt vmcnt(7)
    v_mfma_f32_32x32x16_bf16 v[224:239], a[64:67], v[56:59], v[224:239]
    s_add_u32 s37, s33, 16384
    buffer_load_dwordx4 v[48:51], v5, s[48:51], s37 offen offset:0 sc1
    ds_write_b128 v8, a[252:255] offset:7168
    v_mfma_f32_32x32x16_bf16 v[240:255], a[68:71], v[56:59], v[240:255]
    s_waitcnt vmcnt(7)
    v_mfma_f32_32x32x16_bf16 v[224:239], a[72:75], v[60:63], v[224:239]
    buffer_load_dwordx4 v[52:55], v5, s[48:51], s37 offen offset:1024 sc1
    v_mfma_f32_32x32x16_bf16 v[240:255], a[76:79], v[60:63], v[240:255]
    s_waitcnt vmcnt(7)
    v_mfma_f32_32x32x16_bf16 v[224:239], a[80:83], v[64:67], v[224:239]
    buffer_load_dwordx4 v[56:59], v5, s[48:51], s37 offen offset:2048 sc1
    v_mfma_f32_32x32x16_bf16 v[240:255], a[84:87], v[64:67], v[240:255]
    s_waitcnt lgkmcnt(0)
    s_barrier
    ds_read2_b32 v[16:17], v11 offset0:0 offset1:16
    ds_read2_b32 v[18:19], v11 offset0:64 offset1:80
    ds_read2_b32 v[20:21], v11 offset0:32 offset1:48
    ds_read2_b32 v[22:23], v11 offset0:96 offset1:112
    s_waitcnt vmcnt(7)
    v_mfma_f32_32x32x16_bf16 v[224:239], a[88:91], v[68:71], v[224:239]
    buffer_load_dwordx4 v[60:63], v5, s[48:51], s37 offen offset:3072 sc1
    ds_read_b128 v[96:99], v12 offset:0
    ds_read_b128 v[100:103], v12 offset:16384
    v_mfma_f32_32x32x16_bf16 v[240:255], a[92:95], v[68:71], v[240:255]
    ds_read_b128 v[104:107], v12 offset:32768
    ds_read_b128 v[108:111], v12 offset:49152
    s_waitcnt vmcnt(7)
    v_mfma_f32_32x32x16_bf16 v[224:239], a[96:99], v[32:35], v[224:239]
    s_add_u32 s37, s33, 20480
    buffer_load_dwordx4 v[64:67], v5, s[48:51], s37 offen offset:0 sc1
    ds_read_b128 v[112:115], v12 offset:1024
    ds_read_b128 v[116:119], v12 offset:17408
    v_mfma_f32_32x32x16_bf16 v[240:255], a[100:103], v[32:35], v[240:255]
    ds_read_b128 v[120:123], v12 offset:33792
    ds_read_b128 v[124:127], v12 offset:50176
    s_waitcnt vmcnt(7)
    v_mfma_f32_32x32x16_bf16 v[224:239], a[104:107], v[36:39], v[224:239]
    buffer_load_dwordx4 v[68:71], v5, s[48:51], s37 offen offset:1024 sc1
    s_waitcnt lgkmcnt(8)
    v_add_f32 v16, v16, v17
    v_add_f32 v18, v18, v19
    v_mfma_f32_32x32x16_bf16 v[240:255], a[108:111], v[36:39], v[240:255]
    v_add_f32 v20, v20, v21
    v_add_f32 v22, v22, v23
    v_add_f32 v14, v16, v18
    s_waitcnt vmcnt(7)
    v_mfma_f32_32x32x16_bf16 v[224:239], a[112:115], v[40:43], v[224:239]
    buffer_load_dwordx4 v[32:35], v5, s[48:51], s37 offen offset:2048 sc1
    v_add_f32 v15, v20, v22
    v_mul_f32 v14, 0x3b000000, v14
    v_mul_f32 v15, 0x3b000000, v15
    v_mfma_f32_32x32x16_bf16 v[240:255], a[116:119], v[40:43], v[240:255]
    v_max_f32 v14, 0, v14
    v_max_f32 v15, 0, v15
    v_cvt_pk_bf16_f32 v14, v14, v14
    s_waitcnt vmcnt(7)
    v_mfma_f32_32x32x16_bf16 v[224:239], a[120:123], v[44:47], v[224:239]
    buffer_load_dwordx4 v[36:39], v5, s[48:51], s37 offen offset:3072 sc1
    v_cvt_pk_bf16_f32 v15, v15, v15
    v_and_b32 v14, 0xffff0000, v14
    v_and_b32 v15, 0xffff0000, v15
    v_mfma_f32_32x32x16_bf16 v[240:255], a[124:127], v[44:47], v[240:255]
    v_add_f32 v14, 0x3727c5ac, v14
    v_add_f32 v15, 0x3727c5ac, v15
    v_cvt_pk_bf16_f32 v14, v14, v14
    s_waitcnt vmcnt(7)
    v_mfma_f32_32x32x16_bf16 v[224:239], a[128:131], v[48:51], v[224:239]
    s_add_u32 s37, s33, 24576
    buffer_load_dwordx4 v[40:43], v5, s[48:51], s37 offen offset:0 sc1
    v_cvt_pk_bf16_f32 v15, v15, v15
    v_and_b32 v14, 0xffff0000, v14
    v_and_b32 v15, 0xffff0000, v15
    v_mfma_f32_32x32x16_bf16 v[240:255], a[132:135], v[48:51], v[240:255]
    v_sqrt_f32 v14, v14
    v_sqrt_f32 v15, v15
    v_cvt_pk_bf16_f32 v14, v14, v14
    s_waitcnt vmcnt(7)
    v_mfma_f32_32x32x16_bf16 v[224:239], a[136:139], v[52:55], v[224:239]
    buffer_load_dwordx4 v[44:47], v5, s[48:51], s37 offen offset:1024 sc1
    v_cvt_pk_bf16_f32 v15, v15, v15
    v_and_b32 v14, 0xffff0000, v14
    v_and_b32 v15, 0xffff0000, v15
    v_mfma_f32_32x32x16_bf16 v[240:255], a[140:143], v[52:55], v[240:255]
    v_rcp_f32 v14, v14
    v_rcp_f32 v15, v15
    s_waitcnt lgkmcnt(4)
    s_waitcnt vmcnt(7)
    v_mfma_f32_32x32x16_bf16 v[224:239], a[144:147], v[56:59], v[224:239]
    buffer_load_dwordx4 v[48:51], v5, s[48:51], s37 offen offset:2048 sc1
    v_pk_add_f32 v[96:97], v[96:97], v[100:101]
    v_pk_add_f32 v[104:105], v[104:105], v[108:109]
    v_pk_add_f32 v[98:99], v[98:99], v[102:103]
    v_mfma_f32_32x32x16_bf16 v[240:255], a[148:151], v[56:59], v[240:255]
    v_pk_add_f32 v[106:107], v[106:107], v[110:111]
    v_pk_add_f32 v[96:97], v[96:97], v[104:105]
    v_pk_add_f32 v[98:99], v[98:99], v[106:107]
    s_waitcnt vmcnt(7)
    v_mfma_f32_32x32x16_bf16 v[224:239], a[152:155], v[60:63], v[224:239]
    buffer_load_dwordx4 v[52:55], v5, s[48:51], s37 offen offset:3072 sc1
    v_pk_fma_f32 v[96:97], v[96:97], v[14:15], v[160:161] op_sel:[0,0,0] op_sel_hi:[1,0,1]
    v_pk_fma_f32 v[98:99], v[98:99], v[14:15], v[162:163] op_sel:[0,0,0] op_sel_hi:[1,0,1]
    v_cvt_pk_bf16_f32 v140, v96, v97
    v_mfma_f32_32x32x16_bf16 v[240:255], a[156:159], v[60:63], v[240:255]
    v_cvt_pk_bf16_f32 v141, v98, v99
    s_waitcnt lgkmcnt(0)
    v_pk_add_f32 v[112:113], v[112:113], v[116:117]
    s_waitcnt vmcnt(7)
    v_mfma_f32_32x32x16_bf16 v[224:239], a[160:163], v[64:67], v[224:239]
    v_pk_add_f32 v[120:121], v[120:121], v[124:125]
    v_pk_add_f32 v[114:115], v[114:115], v[118:119]
    v_pk_add_f32 v[122:123], v[122:123], v[126:127]
    v_mfma_f32_32x32x16_bf16 v[240:255], a[164:167], v[64:67], v[240:255]
    v_pk_add_f32 v[112:113], v[112:113], v[120:121]
    v_pk_add_f32 v[114:115], v[114:115], v[122:123]
    v_pk_fma_f32 v[112:113], v[112:113], v[14:15], v[164:165] op_sel:[0,0,0] op_sel_hi:[1,0,1]
    s_waitcnt vmcnt(6)
    v_mfma_f32_32x32x16_bf16 v[224:239], a[168:171], v[68:71], v[224:239]
    v_pk_fma_f32 v[114:115], v[114:115], v[14:15], v[166:167] op_sel:[0,0,0] op_sel_hi:[1,0,1]
    v_cvt_pk_bf16_f32 v142, v112, v113
    v_cvt_pk_bf16_f32 v143, v114, v115
    v_mfma_f32_32x32x16_bf16 v[240:255], a[172:175], v[68:71], v[240:255]
    v_permlane32_swap_b32 v140, v142
    v_permlane32_swap_b32 v141, v143
    s_waitcnt vmcnt(5)
    v_mfma_f32_32x32x16_bf16 v[224:239], a[176:179], v[32:35], v[224:239]
    v_mfma_f32_32x32x16_bf16 v[240:255], a[180:183], v[32:35], v[240:255]
    buffer_store_dwordx4 v[140:143], v10, s[60:63], s38 offen
    s_waitcnt vmcnt(5)
    v_mfma_f32_32x32x16_bf16 v[224:239], a[184:187], v[36:39], v[224:239]
    v_mfma_f32_32x32x16_bf16 v[240:255], a[188:191], v[36:39], v[240:255]
    s_waitcnt vmcnt(4)
    v_mfma_f32_32x32x16_bf16 v[224:239], a[192:195], v[40:43], v[224:239]
    v_mfma_f32_32x32x16_bf16 v[240:255], a[196:199], v[40:43], v[240:255]
    s_waitcnt vmcnt(3)
    v_mfma_f32_32x32x16_bf16 v[224:239], a[200:203], v[44:47], v[224:239]
    v_mfma_f32_32x32x16_bf16 v[240:255], a[204:207], v[44:47], v[240:255]
    s_waitcnt vmcnt(2)
    v_mfma_f32_32x32x16_bf16 v[224:239], a[208:211], v[48:51], v[224:239]
    v_mfma_f32_32x32x16_bf16 v[240:255], a[212:215], v[48:51], v[240:255]
    s_waitcnt vmcnt(1)
    v_mfma_f32_32x32x16_bf16 v[224:239], a[216:219], v[52:55], v[224:239]
    v_mfma_f32_32x32x16_bf16 v[240:255], a[220:223], v[52:55], v[240:255]
    s_nop 10
    ds_write_b128 v8, v[224:227] offset:8192
    ds_write_b128 v8, v[228:231] offset:9216
    ds_write_b128 v8, v[232:235] offset:10240
    ds_write_b128 v8, v[236:239] offset:11264
    ds_write_b128 v8, v[240:243] offset:12288
    ds_write_b128 v8, v[244:247] offset:13312
    ds_write_b128 v8, v[248:251] offset:14336
    ds_write_b128 v8, v[252:255] offset:15360
    s_waitcnt lgkmcnt(0)
    s_barrier
    ds_read_b128 v[96:99], v12 offset:8192
    ds_read_b128 v[100:103], v12 offset:24576
    ds_read_b128 v[104:107], v12 offset:40960
    ds_read_b128 v[108:111], v12 offset:57344
    ds_read_b128 v[112:115], v12 offset:9216
    ds_read_b128 v[116:119], v12 offset:25600
    ds_read_b128 v[120:123], v12 offset:41984
    ds_read_b128 v[124:127], v12 offset:58368
    s_waitcnt lgkmcnt(4)
    v_pk_add_f32 v[96:97], v[96:97], v[100:101]
    v_pk_add_f32 v[104:105], v[104:105], v[108:109]
    v_pk_add_f32 v[98:99], v[98:99], v[102:103]
    v_pk_add_f32 v[106:107], v[106:107], v[110:111]
    v_pk_add_f32 v[96:97], v[96:97], v[104:105]
    v_pk_add_f32 v[98:99], v[98:99], v[106:107]
    v_pk_fma_f32 v[96:97], v[96:97], v[14:15], v[168:169] op_sel:[0,1,0] op_sel_hi:[1,1,1]
    v_pk_fma_f32 v[98:99], v[98:99], v[14:15], v[170:171] op_sel:[0,1,0] op_sel_hi:[1,1,1]
    v_cvt_pk_bf16_f32 v144, v96, v97
    v_cvt_pk_bf16_f32 v145, v98, v99
    s_waitcnt lgkmcnt(0)
    v_pk_add_f32 v[112:113], v[112:113], v[116:117]
    v_pk_add_f32 v[120:121], v[120:121], v[124:125]
    v_pk_add_f32 v[114:115], v[114:115], v[118:119]
    v_pk_add_f32 v[122:123], v[122:123], v[126:127]
    v_pk_add_f32 v[112:113], v[112:113], v[120:121]
    v_pk_add_f32 v[114:115], v[114:115], v[122:123]
    v_pk_fma_f32 v[112:113], v[112:113], v[14:15], v[172:173] op_sel:[0,1,0] op_sel_hi:[1,1,1]
    v_pk_fma_f32 v[114:115], v[114:115], v[14:15], v[174:175] op_sel:[0,1,0] op_sel_hi:[1,1,1]
    v_cvt_pk_bf16_f32 v146, v112, v113
    v_cvt_pk_bf16_f32 v147, v114, v115
    s_nop 0
    v_permlane32_swap_b32 v144, v146
    v_permlane32_swap_b32 v145, v147
    buffer_store_dwordx4 v[144:147], v10, s[60:63], s39 offen
L_END:
    s_endpgm
.fill 4096, 4, 0xBF800000
.section .rodata,"a"
.p2align 6
.amdhsa_kernel sequential_preLN__ssm_conv_h3__dense_activation_relu__prompt_kernel
  .amdhsa_next_free_vgpr 512
  .amdhsa_next_free_sgpr 102
  .amdhsa_accum_offset 256
  .amdhsa_group_segment_fixed_size 0
  .amdhsa_kernarg_size 96
  .amdhsa_user_sgpr_count 2
  .amdhsa_user_sgpr_kernarg_segment_ptr 1
  .amdhsa_system_sgpr_workgroup_id_x 1
  .amdhsa_float_denorm_mode_32 3
.end_amdhsa_kernel
```
